```python
import torch

def _softmax(x, axis=-1):
    return torch.softmax(x, dim=axis)
def _gelu(x):
    return torch.nn.functional.gelu(x, approximate="tanh")
def _silu(x):
    return torch.nn.functional.silu(x)
def _sigmoid(x):
    return torch.sigmoid(x)
def _layernorm(x, axis=-1, eps=1e-5):
    m = x.mean(dim=axis, keepdim=True)
    v = x.var(dim=axis, keepdim=True, unbiased=False)
    return (x - m) / torch.sqrt(v + eps)
def _scatter_add(tgt, idx, src, axis=0):
    return tgt.clone().index_add_(axis, idx, src)
def _segment_sum(src, seg, n):
    out = torch.zeros((n,) + src.shape[1:], dtype=src.dtype)
    return out.index_add_(0, seg, src)
def _pad(x, pw):
    flat = tuple(v for pair in reversed(pw) for v in pair)
    return torch.nn.functional.pad(x, flat)

kernel_name = 'standalone__swiglu_ffn__sampling'

def setup_inputs():

    _w = (lambda a: (lambda t: t.to(torch.bfloat16) if t.is_floating_point() else t)(torch.as_tensor(a)))
    B, S, D, F = 32, 32, 512, 1792
    return {
        "x": _w((lambda *s: torch.randn(*s, dtype=torch.bfloat16) * 0.05)(B, S, D)),
        "w_gate": _w((lambda *s: torch.randn(*s, dtype=torch.bfloat16) * 0.05)(D, F)),
        "w_up": _w((lambda *s: torch.randn(*s, dtype=torch.bfloat16) * 0.05)(D, F)),
        "w_down": _w((lambda *s: torch.randn(*s, dtype=torch.bfloat16) * 0.05)(F, D)),
    }

def reference(x, w_gate, w_up, w_down):
    g = _silu(x @ w_gate)
    u = x @ w_up
    return (g * u) @ w_down
```

```asm
; @launch grid=(256,1,1) block=(512,1,1) lds=163840
.amdgcn_target "amdgcn-amd-amdhsa--gfx950"
.text
.globl standalone__swiglu_ffn__sampling_kernel
.p2align 8
.type standalone__swiglu_ffn__sampling_kernel,@function
standalone__swiglu_ffn__sampling_kernel:
    s_cmp_ge_u32 s2, 256
    s_cbranch_scc1 L_end
    s_load_dwordx2 s[16:17], s[0:1], 8
    s_load_dwordx2 s[20:21], s[0:1], 16
    s_load_dwordx2 s[12:13], s[0:1], 0
    s_load_dwordx2 s[28:29], s[0:1], 24
    s_load_dwordx2 s[32:33], s[0:1], 32
    s_load_dwordx2 s[36:37], s[0:1], 40
    s_load_dwordx2 s[24:25], s[0:1], 48
    v_lshrrev_b32 v2, 6, v0
    v_and_b32 v1, 63, v0
    v_readfirstlane_b32 s38, v2
    v_lshrrev_b32 v2, 3, v1
    v_lshrrev_b32 v3, 4, v1
    v_and_b32 v4, 7, v1
    s_mov_b32 s14, 0x100000
    s_mov_b32 s15, 0x20000
    s_mov_b32 s18, 0x1c0000
    s_mov_b32 s19, 0x20000
    s_mov_b32 s22, 0x1c0000
    s_mov_b32 s23, 0x20000
    s_mov_b32 s30, 0x1c0000
    s_mov_b32 s31, 0x20000
    s_mov_b32 s26, 0x500000
    s_mov_b32 s27, 0x20000
    s_mov_b32 s34, 0x100000
    s_mov_b32 s35, 0x20000
    s_and_b32 s50, s2, 1
    s_lshl_b32 s50, s50, 2
    s_bfe_u32 s51, s2, 0x20003
    s_add_u32 s40, s50, s51
    s_bfe_u32 s50, s2, 0x20001
    s_mul_i32 s50, s50, 7
    s_lshr_b32 s52, s2, 5
    s_add_u32 s41, s50, s52
    s_lshl_b32 s51, s51, 1
    s_add_u32 s42, s51, s52
    s_and_b32 s39, s38, 3
    s_cmp_lt_u32 s38, 4
    s_cbranch_scc1 L_compute
    v_xor_b32 v5, v4, v3
    v_lshlrev_b32 v5, 4, v5
    v_lshl_add_u32 v5, v2, 10, v5
    s_lshl_b32 s50, s40, 17
    s_lshl_b32 s51, s39, 15
    s_add_u32 s50, s50, s51
    v_add_u32 v10, s50, v5
    v_xor_b32 v11, 64, v10
    v_add_u32 v11, 0x2000, v11
    v_add_u32 v12, 0x4000, v10
    v_add_u32 v13, 0x4000, v11
    v_and_b32 v5, 2, v2
    v_xor_b32 v5, v5, v4
    v_lshlrev_b32 v5, 4, v5
    v_mul_u32_u24 v6, 3584, v2
    v_add_u32 v5, v5, v6
    s_mul_i32 s50, s39, 57344
    s_lshl_b32 s51, s41, 7
    s_add_u32 s50, s50, s51
    v_add_u32 v14, s50, v5
    v_xor_b32 v15, 64, v14
    v_add_u32 v15, 28672, v15
    s_lshl_b32 s45, s39, 12
    s_lshl_b32 s46, s39, 11
    s_add_u32 s46, s46, 16384
    s_waitcnt lgkmcnt(0)
    s_cmp_ge_u32 s2, 224
    s_cbranch_scc1 L_l_idle
    s_add_u32 s48, s42, 0
    s_and_b32 s48, s48, 7
    s_lshl_b32 s47, s48, 7
    s_mul_i32 s48, s48, 229376
    s_add_u32 m0, s45, 0
    s_nop 0
    buffer_load_dwordx4 v10, s[12:15], s47 offen lds
    s_add_u32 m0, s45, 1024
    s_nop 0
    buffer_load_dwordx4 v11, s[12:15], s47 offen lds
    s_add_u32 m0, s45, 2048
    s_nop 0
    buffer_load_dwordx4 v12, s[12:15], s47 offen lds
    s_add_u32 m0, s45, 3072
    s_nop 0
    buffer_load_dwordx4 v13, s[12:15], s47 offen lds
    s_add_u32 m0, s46, 0
    s_nop 0
    buffer_load_dwordx4 v14, s[16:19], s48 offen lds
    s_add_u32 m0, s46, 8192
    s_nop 0
    buffer_load_dwordx4 v14, s[20:23], s48 offen lds
    s_add_u32 m0, s46, 1024
    s_nop 0
    buffer_load_dwordx4 v15, s[16:19], s48 offen lds
    s_add_u32 m0, s46, 9216
    s_nop 0
    buffer_load_dwordx4 v15, s[20:23], s48 offen lds
    s_add_u32 s48, s42, 1
    s_and_b32 s48, s48, 7
    s_lshl_b32 s47, s48, 7
    s_mul_i32 s48, s48, 229376
    s_add_u32 m0, s45, 32768
    s_nop 0
    buffer_load_dwordx4 v10, s[12:15], s47 offen lds
    s_add_u32 m0, s45, 33792
    s_nop 0
    buffer_load_dwordx4 v11, s[12:15], s47 offen lds
    s_add_u32 m0, s45, 34816
    s_nop 0
    buffer_load_dwordx4 v12, s[12:15], s47 offen lds
    s_add_u32 m0, s45, 35840
    s_nop 0
    buffer_load_dwordx4 v13, s[12:15], s47 offen lds
    s_add_u32 m0, s46, 32768
    s_nop 0
    buffer_load_dwordx4 v14, s[16:19], s48 offen lds
    s_add_u32 m0, s46, 40960
    s_nop 0
    buffer_load_dwordx4 v14, s[20:23], s48 offen lds
    s_add_u32 m0, s46, 33792
    s_nop 0
    buffer_load_dwordx4 v15, s[16:19], s48 offen lds
    s_add_u32 m0, s46, 41984
    s_nop 0
    buffer_load_dwordx4 v15, s[20:23], s48 offen lds
    s_lshl_b32 s74, s39, 13
    s_lshl_b32 s75, s39, 12
    s_add_u32 s75, s75, 131072
    s_bfe_u32 s50, s2, 0x20003
    s_and_b32 s51, s2, 1
    s_lshl_b32 s51, s51, 2
    s_add_u32 s44, s50, s51
    s_bfe_u32 s51, s2, 0x20001
    s_lshl_b32 s51, s51, 3
    s_lshr_b32 s52, s2, 5
    s_add_u32 s43, s51, s52
    s_mul_i32 s50, s50, 7
    s_lshr_b32 s50, s50, 2
    s_lshl_b32 s60, s50, 10
    s_add_u32 s61, s60, 1024
    s_cmp_eq_u32 s61, 7168
    s_cselect_b32 s61, 0, s61
    s_add_u32 s62, s61, 1024
    s_cmp_eq_u32 s62, 7168
    s_cselect_b32 s62, 0, s62
    s_add_u32 s63, s62, 1024
    s_cmp_eq_u32 s63, 7168
    s_cselect_b32 s63, 0, s63
    s_add_u32 s64, s63, 1024
    s_cmp_eq_u32 s64, 7168
    s_cselect_b32 s64, 0, s64
    s_add_u32 s65, s64, 1024
    s_cmp_eq_u32 s65, 7168
    s_cselect_b32 s65, 0, s65
    s_add_u32 s66, s65, 1024
    s_cmp_eq_u32 s66, 7168
    s_cselect_b32 s66, 0, s66
    v_lshrrev_b32 v2, 2, v1
    v_lshlrev_b32 v3, 7, v2
    v_and_b32 v4, 6, v2
    v_bfe_u32 v5, v1, 1, 1
    v_or_b32 v4, v4, v5
    v_lshl_add_u32 v3, v4, 4, v3
    v_and_b32 v4, 1, v1
    v_lshl_add_u32 v3, v4, 3, v3
    v_xor_b32 v4, 0, v3
    v_add_u32 v232, s74, v4
    v_add_u32 v236, 0x10000, v232
    v_add_u32 v240, s75, v4
    v_xor_b32 v4, 32, v3
    v_add_u32 v233, s74, v4
    v_add_u32 v237, 0x10000, v233
    v_add_u32 v241, s75, v4
    v_xor_b32 v4, 64, v3
    v_add_u32 v234, s74, v4
    v_add_u32 v238, 0x10000, v234
    v_add_u32 v242, s75, v4
    v_xor_b32 v4, 96, v3
    v_add_u32 v235, s74, v4
    v_add_u32 v239, 0x10000, v235
    v_add_u32 v243, s75, v4
    s_mul_i32 s50, s43, 112
    s_mov_b32 s70, s38
    s_mul_i32 s51, s70, 7
    s_add_u32 s50, s50, s51
    s_lshl_b32 s50, s50, 10
    v_lshlrev_b32 v20, 4, v1
    v_add_u32 v20, s50, v20
    v_add_u32 v21, 57344, v20
    v_and_b32 v3, 15, v1
    v_lshlrev_b32 v3, 8, v3
    s_add_u32 s50, s74, 0x10000
    v_add_u32 v3, s50, v3
    v_lshrrev_b32 v4, 4, v1
    v_and_b32 v5, 7, v1
    v_xor_b32 v4, v4, v5
    v_lshl_add_u32 v24, v4, 4, v3
    v_xor_b32 v25, 64, v24
    v_lshrrev_b32 v2, 4, v0
    v_and_b32 v3, 7, v2
    v_and_b32 v4, 15, v0
    v_xor_b32 v3, v3, v4
    v_lshlrev_b32 v3, 4, v3
    v_lshl_add_u32 v22, v2, 8, v3
    v_add_u32 v22, 0x10000, v22
    v_lshlrev_b32 v4, 3, v4
    v_lshl_add_u32 v23, v2, 10, v4
    s_lshl_b32 s50, s43, 15
    s_lshl_b32 s51, s44, 7
    s_add_u32 s50, s50, s51
    v_add_u32 v23, s50, v23
    s_lshr_b32 s50, s43, 2
    s_lshl_b32 s51, s50, 5
    v_mov_b32 v27, s51
    s_lshl_b32 s50, s50, 12
    s_mul_i32 s51, s38, 7
    s_lshr_b32 s51, s51, 1
    s_lshl_b32 s51, s51, 7
    s_add_u32 s77, s50, s51
    s_add_u32 s77, s77, 0x400000
    v_and_b32 v26, 3, v1
    v_lshlrev_b32 v26, 7, v26
    v_min_u32 v26, 27, v1
    v_lshlrev_b32 v26, 7, v26
    s_add_u32 s77, s50, 0x400000
    v_mov_b32 v30, 155648
    v_mov_b32 v31, 1
    v_lshrrev_b32 v2, 3, v1
    v_and_b32 v4, 7, v1
    v_and_b32 v5, 6, v2
    v_xor_b32 v5, v5, v4
    v_lshlrev_b32 v5, 4, v5
    v_lshl_add_u32 v5, v2, 10, v5
    s_lshl_b32 s51, s44, 7
    s_mul_i32 s50, s70, 229376
    s_add_u32 s50, s50, s51
    v_add_u32 v16, s50, v5
    s_xor_b32 s50, s70, 4
    s_mul_i32 s50, s50, 229376
    s_add_u32 s50, s50, s51
    v_add_u32 v17, s50, v5
    s_waitcnt vmcnt(8)
    s_barrier
    s_add_u32 s48, s42, 2
    s_and_b32 s48, s48, 7
    s_lshl_b32 s47, s48, 7
    s_mul_i32 s48, s48, 229376
    s_add_u32 m0, s45, 65536
    s_nop 0
    buffer_load_dwordx4 v10, s[12:15], s47 offen lds
    s_add_u32 m0, s45, 66560
    s_nop 0
    buffer_load_dwordx4 v11, s[12:15], s47 offen lds
    s_add_u32 m0, s45, 67584
    s_nop 0
    buffer_load_dwordx4 v12, s[12:15], s47 offen lds
    s_add_u32 m0, s45, 68608
    s_nop 0
    buffer_load_dwordx4 v13, s[12:15], s47 offen lds
    s_add_u32 m0, s46, 65536
    s_nop 0
    buffer_load_dwordx4 v14, s[16:19], s48 offen lds
    s_add_u32 m0, s46, 73728
    s_nop 0
    buffer_load_dwordx4 v14, s[20:23], s48 offen lds
    s_add_u32 m0, s46, 66560
    s_nop 0
    buffer_load_dwordx4 v15, s[16:19], s48 offen lds
    s_add_u32 m0, s46, 74752
    s_nop 0
    buffer_load_dwordx4 v15, s[20:23], s48 offen lds
    s_waitcnt vmcnt(8)
    s_barrier
    s_add_u32 s48, s42, 3
    s_and_b32 s48, s48, 7
    s_lshl_b32 s47, s48, 7
    s_mul_i32 s48, s48, 229376
    s_add_u32 m0, s45, 98304
    s_nop 0
    buffer_load_dwordx4 v10, s[12:15], s47 offen lds
    s_add_u32 m0, s45, 99328
    s_nop 0
    buffer_load_dwordx4 v11, s[12:15], s47 offen lds
    s_add_u32 m0, s45, 100352
    s_nop 0
    buffer_load_dwordx4 v12, s[12:15], s47 offen lds
    s_add_u32 m0, s45, 101376
    s_nop 0
    buffer_load_dwordx4 v13, s[12:15], s47 offen lds
    s_add_u32 m0, s46, 98304
    s_nop 0
    buffer_load_dwordx4 v14, s[16:19], s48 offen lds
    s_add_u32 m0, s46, 106496
    s_nop 0
    buffer_load_dwordx4 v14, s[20:23], s48 offen lds
    s_add_u32 m0, s46, 99328
    s_nop 0
    buffer_load_dwordx4 v15, s[16:19], s48 offen lds
    s_add_u32 m0, s46, 107520
    s_nop 0
    buffer_load_dwordx4 v15, s[20:23], s48 offen lds
    s_waitcnt vmcnt(8)
    s_barrier
    s_add_u32 s48, s42, 4
    s_and_b32 s48, s48, 7
    s_lshl_b32 s47, s48, 7
    s_mul_i32 s48, s48, 229376
    s_add_u32 m0, s45, 0
    s_nop 0
    buffer_load_dwordx4 v10, s[12:15], s47 offen lds
    s_add_u32 m0, s45, 1024
    s_nop 0
    buffer_load_dwordx4 v11, s[12:15], s47 offen lds
    s_add_u32 m0, s45, 2048
    s_nop 0
    buffer_load_dwordx4 v12, s[12:15], s47 offen lds
    s_add_u32 m0, s45, 3072
    s_nop 0
    buffer_load_dwordx4 v13, s[12:15], s47 offen lds
    s_add_u32 m0, s46, 0
    s_nop 0
    buffer_load_dwordx4 v14, s[16:19], s48 offen lds
    s_add_u32 m0, s46, 8192
    s_nop 0
    buffer_load_dwordx4 v14, s[20:23], s48 offen lds
    s_add_u32 m0, s46, 1024
    s_nop 0
    buffer_load_dwordx4 v15, s[16:19], s48 offen lds
    s_add_u32 m0, s46, 9216
    s_nop 0
    buffer_load_dwordx4 v15, s[20:23], s48 offen lds
    s_waitcnt vmcnt(8)
    s_barrier
    s_add_u32 s48, s42, 5
    s_and_b32 s48, s48, 7
    s_lshl_b32 s47, s48, 7
    s_mul_i32 s48, s48, 229376
    s_add_u32 m0, s45, 32768
    s_nop 0
    buffer_load_dwordx4 v10, s[12:15], s47 offen lds
    s_add_u32 m0, s45, 33792
    s_nop 0
    buffer_load_dwordx4 v11, s[12:15], s47 offen lds
    s_add_u32 m0, s45, 34816
    s_nop 0
    buffer_load_dwordx4 v12, s[12:15], s47 offen lds
    s_add_u32 m0, s45, 35840
    s_nop 0
    buffer_load_dwordx4 v13, s[12:15], s47 offen lds
    s_add_u32 m0, s46, 32768
    s_nop 0
    buffer_load_dwordx4 v14, s[16:19], s48 offen lds
    s_add_u32 m0, s46, 40960
    s_nop 0
    buffer_load_dwordx4 v14, s[20:23], s48 offen lds
    s_add_u32 m0, s46, 33792
    s_nop 0
    buffer_load_dwordx4 v15, s[16:19], s48 offen lds
    s_add_u32 m0, s46, 41984
    s_nop 0
    buffer_load_dwordx4 v15, s[20:23], s48 offen lds
    s_waitcnt vmcnt(8)
    s_barrier
    s_add_u32 s48, s42, 6
    s_and_b32 s48, s48, 7
    s_lshl_b32 s47, s48, 7
    s_mul_i32 s48, s48, 229376
    s_add_u32 m0, s45, 65536
    s_nop 0
    buffer_load_dwordx4 v10, s[12:15], s47 offen lds
    s_add_u32 m0, s45, 66560
    s_nop 0
    buffer_load_dwordx4 v11, s[12:15], s47 offen lds
    s_add_u32 m0, s45, 67584
    s_nop 0
    buffer_load_dwordx4 v12, s[12:15], s47 offen lds
    s_add_u32 m0, s45, 68608
    s_nop 0
    buffer_load_dwordx4 v13, s[12:15], s47 offen lds
    s_add_u32 m0, s46, 65536
    s_nop 0
    buffer_load_dwordx4 v14, s[16:19], s48 offen lds
    s_add_u32 m0, s46, 73728
    s_nop 0
    buffer_load_dwordx4 v14, s[20:23], s48 offen lds
    s_add_u32 m0, s46, 66560
    s_nop 0
    buffer_load_dwordx4 v15, s[16:19], s48 offen lds
    s_add_u32 m0, s46, 74752
    s_nop 0
    buffer_load_dwordx4 v15, s[20:23], s48 offen lds
    s_waitcnt vmcnt(8)
    s_barrier
    s_add_u32 s48, s42, 7
    s_and_b32 s48, s48, 7
    s_lshl_b32 s47, s48, 7
    s_mul_i32 s48, s48, 229376
    s_add_u32 m0, s45, 98304
    s_nop 0
    buffer_load_dwordx4 v10, s[12:15], s47 offen lds
    s_add_u32 m0, s45, 99328
    s_nop 0
    buffer_load_dwordx4 v11, s[12:15], s47 offen lds
    s_add_u32 m0, s45, 100352
    s_nop 0
    buffer_load_dwordx4 v12, s[12:15], s47 offen lds
    s_add_u32 m0, s45, 101376
    s_nop 0
    buffer_load_dwordx4 v13, s[12:15], s47 offen lds
    s_add_u32 m0, s46, 98304
    s_nop 0
    buffer_load_dwordx4 v14, s[16:19], s48 offen lds
    s_add_u32 m0, s46, 106496
    s_nop 0
    buffer_load_dwordx4 v14, s[20:23], s48 offen lds
    s_add_u32 m0, s46, 99328
    s_nop 0
    buffer_load_dwordx4 v15, s[16:19], s48 offen lds
    s_add_u32 m0, s46, 107520
    s_nop 0
    buffer_load_dwordx4 v15, s[20:23], s48 offen lds
    s_waitcnt vmcnt(8)
    s_barrier
    s_add_u32 m0, s75, 0
    s_lshl_b32 s50, s60, 5
    buffer_load_dwordx4 v16, s[28:31], s50 offen lds
    s_add_u32 m0, s75, 1024
    s_add_u32 s50, s50, 8192
    buffer_load_dwordx4 v16, s[28:31], s50 offen lds
    s_add_u32 m0, s75, 2048
    s_add_u32 s50, s50, 8192
    buffer_load_dwordx4 v16, s[28:31], s50 offen lds
    s_add_u32 m0, s75, 3072
    s_add_u32 s50, s50, 8192
    buffer_load_dwordx4 v16, s[28:31], s50 offen lds
    s_waitcnt vmcnt(4)
    s_barrier
    s_branch L_l_wd
L_l_idle:
    v_lshrrev_b32 v5, 2, v1
    v_and_b32 v6, 3, v1
    v_lshlrev_b32 v6, 7, v6
    v_lshl_add_u32 v5, v5, 10, v6
    s_and_b32 s8, s2, 1
    s_lshl_b32 s8, s8, 9
    s_bfe_u32 s9, s2, 0x20003
    s_mul_i32 s9, s9, 229376
    s_add_u32 s8, s8, s9
    s_lshl_b32 s9, s39, 14
    s_add_u32 s8, s8, s9
    s_add_u32 s9, s8, 917504
    buffer_load_dword v244, v5, s[28:31], s9 offen
    s_add_u32 s9, s8, 983040
    buffer_load_dword v245, v5, s[28:31], s9 offen
    s_add_u32 s9, s8, 1048576
    buffer_load_dword v246, v5, s[28:31], s9 offen
    s_add_u32 s9, s8, 1114112
    s_add_u32 s10, s8, -32768
    s_cmp_lt_u32 s39, 2
    s_cselect_b32 s9, s9, s10
    buffer_load_dword v247, v5, s[28:31], s9 offen
    s_add_u32 s9, s8, 1179648
    s_add_u32 s10, s8, 32768
    s_mov_b32 s9, s10
    buffer_load_dword v248, v5, s[28:31], s9 offen
    s_add_u32 s9, s8, 1245184
    s_add_u32 s10, s8, 98304
    s_mov_b32 s9, s10
    buffer_load_dword v249, v5, s[28:31], s9 offen
    s_add_u32 s9, s8, 1310720
    s_add_u32 s10, s8, 163840
    s_mov_b32 s9, s10
    buffer_load_dword v250, v5, s[28:31], s9 offen
    s_lshl_b32 s74, s39, 13
    s_lshl_b32 s75, s39, 12
    s_add_u32 s75, s75, 131072
    s_bfe_u32 s50, s2, 0x20003
    s_and_b32 s51, s2, 1
    s_lshl_b32 s51, s51, 2
    s_add_u32 s44, s50, s51
    s_bfe_u32 s51, s2, 0x20001
    s_lshl_b32 s51, s51, 3
    s_lshr_b32 s52, s2, 5
    s_add_u32 s43, s51, s52
    s_mul_i32 s50, s50, 7
    s_lshr_b32 s50, s50, 2
    s_lshl_b32 s60, s50, 10
    s_add_u32 s61, s60, 1024
    s_cmp_eq_u32 s61, 7168
    s_cselect_b32 s61, 0, s61
    s_add_u32 s62, s61, 1024
    s_cmp_eq_u32 s62, 7168
    s_cselect_b32 s62, 0, s62
    s_add_u32 s63, s62, 1024
    s_cmp_eq_u32 s63, 7168
    s_cselect_b32 s63, 0, s63
    s_add_u32 s64, s63, 1024
    s_cmp_eq_u32 s64, 7168
    s_cselect_b32 s64, 0, s64
    s_add_u32 s65, s64, 1024
    s_cmp_eq_u32 s65, 7168
    s_cselect_b32 s65, 0, s65
    s_add_u32 s66, s65, 1024
    s_cmp_eq_u32 s66, 7168
    s_cselect_b32 s66, 0, s66
    v_lshrrev_b32 v2, 2, v1
    v_lshlrev_b32 v3, 7, v2
    v_and_b32 v4, 6, v2
    v_bfe_u32 v5, v1, 1, 1
    v_or_b32 v4, v4, v5
    v_lshl_add_u32 v3, v4, 4, v3
    v_and_b32 v4, 1, v1
    v_lshl_add_u32 v3, v4, 3, v3
    v_xor_b32 v4, 0, v3
    v_add_u32 v232, s74, v4
    v_add_u32 v236, 0x10000, v232
    v_add_u32 v240, s75, v4
    v_xor_b32 v4, 32, v3
    v_add_u32 v233, s74, v4
    v_add_u32 v237, 0x10000, v233
    v_add_u32 v241, s75, v4
    v_xor_b32 v4, 64, v3
    v_add_u32 v234, s74, v4
    v_add_u32 v238, 0x10000, v234
    v_add_u32 v242, s75, v4
    v_xor_b32 v4, 96, v3
    v_add_u32 v235, s74, v4
    v_add_u32 v239, 0x10000, v235
    v_add_u32 v243, s75, v4
    s_mul_i32 s50, s43, 112
    s_mov_b32 s70, s38
    s_mul_i32 s51, s70, 7
    s_add_u32 s50, s50, s51
    s_lshl_b32 s50, s50, 10
    v_lshlrev_b32 v20, 4, v1
    v_add_u32 v20, s50, v20
    v_add_u32 v21, 57344, v20
    v_and_b32 v3, 15, v1
    v_lshlrev_b32 v3, 8, v3
    s_add_u32 s50, s74, 0x10000
    v_add_u32 v3, s50, v3
    v_lshrrev_b32 v4, 4, v1
    v_and_b32 v5, 7, v1
    v_xor_b32 v4, v4, v5
    v_lshl_add_u32 v24, v4, 4, v3
    v_xor_b32 v25, 64, v24
    v_lshrrev_b32 v2, 4, v0
    v_and_b32 v3, 7, v2
    v_and_b32 v4, 15, v0
    v_xor_b32 v3, v3, v4
    v_lshlrev_b32 v3, 4, v3
    v_lshl_add_u32 v22, v2, 8, v3
    v_add_u32 v22, 0x10000, v22
    v_lshlrev_b32 v4, 3, v4
    v_lshl_add_u32 v23, v2, 10, v4
    s_lshl_b32 s50, s43, 15
    s_lshl_b32 s51, s44, 7
    s_add_u32 s50, s50, s51
    v_add_u32 v23, s50, v23
    s_lshr_b32 s50, s43, 2
    s_lshl_b32 s51, s50, 5
    v_mov_b32 v27, s51
    s_lshl_b32 s50, s50, 12
    s_mul_i32 s51, s38, 7
    s_lshr_b32 s51, s51, 1
    s_lshl_b32 s51, s51, 7
    s_add_u32 s77, s50, s51
    s_add_u32 s77, s77, 0x400000
    v_and_b32 v26, 3, v1
    v_lshlrev_b32 v26, 7, v26
    v_min_u32 v26, 27, v1
    v_lshlrev_b32 v26, 7, v26
    s_add_u32 s77, s50, 0x400000
    v_mov_b32 v30, 155648
    v_mov_b32 v31, 1
    v_lshrrev_b32 v2, 3, v1
    v_and_b32 v4, 7, v1
    v_and_b32 v5, 6, v2
    v_xor_b32 v5, v5, v4
    v_lshlrev_b32 v5, 4, v5
    v_lshl_add_u32 v5, v2, 10, v5
    s_lshl_b32 s51, s44, 7
    s_mul_i32 s50, s70, 229376
    s_add_u32 s50, s50, s51
    v_add_u32 v16, s50, v5
    s_xor_b32 s50, s70, 4
    s_mul_i32 s50, s50, 229376
    s_add_u32 s50, s50, s51
    v_add_u32 v17, s50, v5
    s_barrier
    s_add_u32 m0, s75, 0
    s_lshl_b32 s50, s60, 5
    buffer_load_dwordx4 v16, s[28:31], s50 offen lds
    s_add_u32 m0, s75, 1024
    s_add_u32 s50, s50, 8192
    buffer_load_dwordx4 v16, s[28:31], s50 offen lds
    s_add_u32 m0, s75, 2048
    s_add_u32 s50, s50, 8192
    buffer_load_dwordx4 v16, s[28:31], s50 offen lds
    s_add_u32 m0, s75, 3072
    s_add_u32 s50, s50, 8192
    buffer_load_dwordx4 v16, s[28:31], s50 offen lds
L_l_wd:
    s_cmp_lg_u32 s39, 0
    s_cbranch_scc1 L_l_nocnt
    global_load_dword v28, v27, s[36:37] sc1
L_l_nocnt:
    s_add_u32 m0, s74, 0
    s_lshl_b32 s50, s61, 5
    s_waitcnt vmcnt(3)
    buffer_load_dwordx4 v16, s[28:31], s50 offen lds
    s_add_u32 m0, s74, 1024
    s_add_u32 s50, s50, 8192
    s_waitcnt vmcnt(3)
    buffer_load_dwordx4 v16, s[28:31], s50 offen lds
    s_add_u32 m0, s74, 2048
    s_add_u32 s50, s50, 8192
    s_waitcnt vmcnt(3)
    buffer_load_dwordx4 v16, s[28:31], s50 offen lds
    s_add_u32 m0, s74, 3072
    s_add_u32 s50, s50, 8192
    s_waitcnt vmcnt(3)
    buffer_load_dwordx4 v16, s[28:31], s50 offen lds
    s_add_u32 m0, s74, 4096
    s_lshl_b32 s50, s62, 5
    s_waitcnt vmcnt(3)
    buffer_load_dwordx4 v16, s[28:31], s50 offen lds
    s_add_u32 m0, s74, 5120
    s_add_u32 s50, s50, 8192
    s_waitcnt vmcnt(3)
    buffer_load_dwordx4 v16, s[28:31], s50 offen lds
    s_add_u32 m0, s74, 6144
    s_add_u32 s50, s50, 8192
    s_waitcnt vmcnt(3)
    buffer_load_dwordx4 v16, s[28:31], s50 offen lds
    s_add_u32 m0, s74, 7168
    s_add_u32 s50, s50, 8192
    s_waitcnt vmcnt(3)
    buffer_load_dwordx4 v16, s[28:31], s50 offen lds
    s_add_u32 m0, s74, 32768
    s_lshl_b32 s50, s63, 5
    s_waitcnt vmcnt(3)
    buffer_load_dwordx4 v16, s[28:31], s50 offen lds
    s_add_u32 m0, s74, 33792
    s_add_u32 s50, s50, 8192
    s_waitcnt vmcnt(3)
    buffer_load_dwordx4 v16, s[28:31], s50 offen lds
    s_add_u32 m0, s74, 34816
    s_add_u32 s50, s50, 8192
    s_waitcnt vmcnt(3)
    buffer_load_dwordx4 v16, s[28:31], s50 offen lds
    s_add_u32 m0, s74, 35840
    s_add_u32 s50, s50, 8192
    s_waitcnt vmcnt(3)
    buffer_load_dwordx4 v16, s[28:31], s50 offen lds
    s_add_u32 m0, s74, 36864
    s_lshl_b32 s50, s64, 5
    s_waitcnt vmcnt(3)
    buffer_load_dwordx4 v16, s[28:31], s50 offen lds
    s_add_u32 m0, s74, 37888
    s_add_u32 s50, s50, 8192
    s_waitcnt vmcnt(3)
    buffer_load_dwordx4 v16, s[28:31], s50 offen lds
    s_add_u32 m0, s74, 38912
    s_add_u32 s50, s50, 8192
    s_waitcnt vmcnt(3)
    buffer_load_dwordx4 v16, s[28:31], s50 offen lds
    s_add_u32 m0, s74, 39936
    s_add_u32 s50, s50, 8192
    s_waitcnt vmcnt(3)
    buffer_load_dwordx4 v16, s[28:31], s50 offen lds
    s_add_u32 m0, s74, 65536
    s_lshl_b32 s50, s65, 5
    s_waitcnt vmcnt(3)
    buffer_load_dwordx4 v16, s[28:31], s50 offen lds
    s_add_u32 m0, s74, 66560
    s_add_u32 s50, s50, 8192
    s_waitcnt vmcnt(3)
    buffer_load_dwordx4 v16, s[28:31], s50 offen lds
    s_add_u32 m0, s74, 67584
    s_add_u32 s50, s50, 8192
    s_waitcnt vmcnt(3)
    buffer_load_dwordx4 v16, s[28:31], s50 offen lds
    s_add_u32 m0, s74, 68608
    s_add_u32 s50, s50, 8192
    s_waitcnt vmcnt(3)
    buffer_load_dwordx4 v16, s[28:31], s50 offen lds
    s_add_u32 m0, s74, 69632
    s_lshl_b32 s50, s66, 5
    s_waitcnt vmcnt(3)
    buffer_load_dwordx4 v16, s[28:31], s50 offen lds
    s_add_u32 m0, s74, 70656
    s_add_u32 s50, s50, 8192
    s_waitcnt vmcnt(3)
    buffer_load_dwordx4 v16, s[28:31], s50 offen lds
    s_add_u32 m0, s74, 71680
    s_add_u32 s50, s50, 8192
    s_waitcnt vmcnt(3)
    buffer_load_dwordx4 v16, s[28:31], s50 offen lds
    s_add_u32 m0, s74, 72704
    s_add_u32 s50, s50, 8192
    s_waitcnt vmcnt(3)
    buffer_load_dwordx4 v16, s[28:31], s50 offen lds
    s_waitcnt vmcnt(24)
    ds_read_b64_tr_b16 v[32:33], v240 offset:0
    ds_read_b64_tr_b16 v[34:35], v240 offset:2048
    ds_read_b64_tr_b16 v[36:37], v241 offset:0
    ds_read_b64_tr_b16 v[38:39], v241 offset:2048
    ds_read_b64_tr_b16 v[40:41], v242 offset:0
    ds_read_b64_tr_b16 v[42:43], v242 offset:2048
    ds_read_b64_tr_b16 v[44:45], v243 offset:0
    ds_read_b64_tr_b16 v[46:47], v243 offset:2048
    s_waitcnt lgkmcnt(0)
    s_add_u32 m0, s75, 0
    s_lshl_b32 s50, s62, 5
    s_waitcnt vmcnt(3)
    buffer_load_dwordx4 v17, s[28:31], s50 offen lds
    s_add_u32 m0, s75, 1024
    s_add_u32 s50, s50, 8192
    s_waitcnt vmcnt(3)
    buffer_load_dwordx4 v17, s[28:31], s50 offen lds
    s_add_u32 m0, s75, 2048
    s_add_u32 s50, s50, 8192
    s_waitcnt vmcnt(3)
    buffer_load_dwordx4 v17, s[28:31], s50 offen lds
    s_add_u32 m0, s75, 3072
    s_add_u32 s50, s50, 8192
    s_waitcnt vmcnt(3)
    buffer_load_dwordx4 v17, s[28:31], s50 offen lds
    s_waitcnt vmcnt(20)
    ds_read_b64_tr_b16 v[48:49], v232 offset:0
    ds_read_b64_tr_b16 v[50:51], v232 offset:2048
    ds_read_b64_tr_b16 v[52:53], v233 offset:0
    ds_read_b64_tr_b16 v[54:55], v233 offset:2048
    ds_read_b64_tr_b16 v[56:57], v234 offset:0
    ds_read_b64_tr_b16 v[58:59], v234 offset:2048
    ds_read_b64_tr_b16 v[60:61], v235 offset:0
    ds_read_b64_tr_b16 v[62:63], v235 offset:2048
    s_waitcnt lgkmcnt(4)
    ds_read_b64_tr_b16 v[64:65], v232 offset:4096
    ds_read_b64_tr_b16 v[66:67], v232 offset:6144
    ds_read_b64_tr_b16 v[68:69], v233 offset:4096
    ds_read_b64_tr_b16 v[70:71], v233 offset:6144
    ds_read_b64_tr_b16 v[72:73], v234 offset:4096
    ds_read_b64_tr_b16 v[74:75], v234 offset:6144
    ds_read_b64_tr_b16 v[76:77], v235 offset:4096
    ds_read_b64_tr_b16 v[78:79], v235 offset:6144
    s_waitcnt lgkmcnt(0)
    s_add_u32 m0, s74, 0
    s_lshl_b32 s50, s63, 5
    s_waitcnt vmcnt(3)
    buffer_load_dwordx4 v17, s[28:31], s50 offen lds
    s_add_u32 m0, s74, 1024
    s_add_u32 s50, s50, 8192
    s_waitcnt vmcnt(3)
    buffer_load_dwordx4 v17, s[28:31], s50 offen lds
    s_add_u32 m0, s74, 2048
    s_add_u32 s50, s50, 8192
    s_waitcnt vmcnt(3)
    buffer_load_dwordx4 v17, s[28:31], s50 offen lds
    s_add_u32 m0, s74, 3072
    s_add_u32 s50, s50, 8192
    s_waitcnt vmcnt(3)
    buffer_load_dwordx4 v17, s[28:31], s50 offen lds
    s_add_u32 m0, s74, 4096
    s_lshl_b32 s50, s64, 5
    s_waitcnt vmcnt(3)
    buffer_load_dwordx4 v17, s[28:31], s50 offen lds
    s_add_u32 m0, s74, 5120
    s_add_u32 s50, s50, 8192
    s_waitcnt vmcnt(3)
    buffer_load_dwordx4 v17, s[28:31], s50 offen lds
    s_add_u32 m0, s74, 6144
    s_add_u32 s50, s50, 8192
    s_waitcnt vmcnt(3)
    buffer_load_dwordx4 v17, s[28:31], s50 offen lds
    s_add_u32 m0, s74, 7168
    s_add_u32 s50, s50, 8192
    s_waitcnt vmcnt(3)
    buffer_load_dwordx4 v17, s[28:31], s50 offen lds
    s_cmp_ge_u32 s2, 224
    s_cbranch_scc1 L_spd_s3
    s_mov_b32 s76, 0
L_sp_s3:
    ds_read_b32 v2, v30 offset:4
    s_add_u32 s76, s76, 1
    s_waitcnt lgkmcnt(0)
    v_readfirstlane_b32 s51, v2
    s_cmp_lt_u32 s76, 0x400000
    s_cbranch_scc0 L_spd_s3
    s_cmp_ge_u32 s51, 256
    s_cbranch_scc1 L_spd_s3
    s_sleep 1
    s_branch L_sp_s3
L_spd_s3:
    s_add_u32 m0, s74, 98304
    s_lshl_b32 s50, s60, 5
    s_waitcnt vmcnt(3)
    buffer_load_dwordx4 v17, s[28:31], s50 offen lds
    s_add_u32 m0, s74, 99328
    s_add_u32 s50, s50, 8192
    s_waitcnt vmcnt(3)
    buffer_load_dwordx4 v17, s[28:31], s50 offen lds
    s_add_u32 m0, s74, 100352
    s_add_u32 s50, s50, 8192
    s_waitcnt vmcnt(3)
    buffer_load_dwordx4 v17, s[28:31], s50 offen lds
    s_add_u32 m0, s74, 101376
    s_add_u32 s50, s50, 8192
    s_waitcnt vmcnt(3)
    buffer_load_dwordx4 v17, s[28:31], s50 offen lds
    s_add_u32 m0, s74, 102400
    s_lshl_b32 s50, s61, 5
    s_waitcnt vmcnt(3)
    buffer_load_dwordx4 v17, s[28:31], s50 offen lds
    s_add_u32 m0, s74, 103424
    s_add_u32 s50, s50, 8192
    s_waitcnt vmcnt(3)
    buffer_load_dwordx4 v17, s[28:31], s50 offen lds
    s_add_u32 m0, s74, 104448
    s_add_u32 s50, s50, 8192
    s_waitcnt vmcnt(3)
    buffer_load_dwordx4 v17, s[28:31], s50 offen lds
    s_add_u32 m0, s74, 105472
    s_add_u32 s50, s50, 8192
    s_waitcnt vmcnt(3)
    buffer_load_dwordx4 v17, s[28:31], s50 offen lds
    s_waitcnt vmcnt(28)
    ds_read_b64_tr_b16 v[80:81], v232 offset:32768
    ds_read_b64_tr_b16 v[82:83], v232 offset:34816
    ds_read_b64_tr_b16 v[84:85], v233 offset:32768
    ds_read_b64_tr_b16 v[86:87], v233 offset:34816
    ds_read_b64_tr_b16 v[88:89], v234 offset:32768
    ds_read_b64_tr_b16 v[90:91], v234 offset:34816
    ds_read_b64_tr_b16 v[92:93], v235 offset:32768
    ds_read_b64_tr_b16 v[94:95], v235 offset:34816
    s_waitcnt lgkmcnt(4)
    ds_read_b64_tr_b16 v[96:97], v232 offset:36864
    ds_read_b64_tr_b16 v[98:99], v232 offset:38912
    ds_read_b64_tr_b16 v[100:101], v233 offset:36864
    ds_read_b64_tr_b16 v[102:103], v233 offset:38912
    ds_read_b64_tr_b16 v[104:105], v234 offset:36864
    ds_read_b64_tr_b16 v[106:107], v234 offset:38912
    ds_read_b64_tr_b16 v[108:109], v235 offset:36864
    ds_read_b64_tr_b16 v[110:111], v235 offset:38912
    s_waitcnt lgkmcnt(0)
    s_add_u32 m0, s74, 32768
    s_lshl_b32 s50, s65, 5
    s_waitcnt vmcnt(3)
    buffer_load_dwordx4 v17, s[28:31], s50 offen lds
    s_add_u32 m0, s74, 33792
    s_add_u32 s50, s50, 8192
    s_waitcnt vmcnt(3)
    buffer_load_dwordx4 v17, s[28:31], s50 offen lds
    s_add_u32 m0, s74, 34816
    s_add_u32 s50, s50, 8192
    s_waitcnt vmcnt(3)
    buffer_load_dwordx4 v17, s[28:31], s50 offen lds
    s_add_u32 m0, s74, 35840
    s_add_u32 s50, s50, 8192
    s_waitcnt vmcnt(3)
    buffer_load_dwordx4 v17, s[28:31], s50 offen lds
    s_add_u32 m0, s74, 36864
    s_lshl_b32 s50, s66, 5
    s_waitcnt vmcnt(3)
    buffer_load_dwordx4 v17, s[28:31], s50 offen lds
    s_add_u32 m0, s74, 37888
    s_add_u32 s50, s50, 8192
    s_waitcnt vmcnt(3)
    buffer_load_dwordx4 v17, s[28:31], s50 offen lds
    s_add_u32 m0, s74, 38912
    s_add_u32 s50, s50, 8192
    s_waitcnt vmcnt(3)
    buffer_load_dwordx4 v17, s[28:31], s50 offen lds
    s_add_u32 m0, s74, 39936
    s_add_u32 s50, s50, 8192
    s_waitcnt vmcnt(3)
    buffer_load_dwordx4 v17, s[28:31], s50 offen lds
    s_cmp_lg_u32 s39, 0
    s_cbranch_scc1 L_l_np
    s_mov_b32 s76, 0
L_pc_l:
    v_cmp_gt_u32 vcc, 28, v28
    s_add_u32 s76, s76, 1
    s_cmp_eq_u64 vcc, 0
    s_cbranch_scc1 L_pcd_l
    s_cmp_lt_u32 s76, 0x20000
    s_cbranch_scc0 L_pcd_l
    s_sleep 8
    global_load_dword v28, v27, s[36:37] sc1
    s_waitcnt vmcnt(0)
    s_branch L_pc_l
L_pcd_l:
    buffer_load_dword v29, v26, s[24:27], s77 offen sc1
L_l_np:
    s_waitcnt vmcnt(28)
    ds_read_b64_tr_b16 v[112:113], v236 offset:0
    ds_read_b64_tr_b16 v[114:115], v236 offset:2048
    ds_read_b64_tr_b16 v[116:117], v237 offset:0
    ds_read_b64_tr_b16 v[118:119], v237 offset:2048
    ds_read_b64_tr_b16 v[120:121], v238 offset:0
    ds_read_b64_tr_b16 v[122:123], v238 offset:2048
    ds_read_b64_tr_b16 v[124:125], v239 offset:0
    ds_read_b64_tr_b16 v[126:127], v239 offset:2048
    s_waitcnt lgkmcnt(4)
    ds_read_b64_tr_b16 v[128:129], v236 offset:4096
    ds_read_b64_tr_b16 v[130:131], v236 offset:6144
    ds_read_b64_tr_b16 v[132:133], v237 offset:4096
    ds_read_b64_tr_b16 v[134:135], v237 offset:6144
    ds_read_b64_tr_b16 v[136:137], v238 offset:4096
    ds_read_b64_tr_b16 v[138:139], v238 offset:6144
    ds_read_b64_tr_b16 v[140:141], v239 offset:4096
    ds_read_b64_tr_b16 v[142:143], v239 offset:6144
    s_lshl_b32 s50, s39, 2
    v_add_u32 v3, s50, v30
    s_cmp_lg_u32 s39, 0
    s_cbranch_scc1 L_l_np2
    s_waitcnt vmcnt(1)
    ds_write_b32 v3, v31 offset:8
L_pl_l:
    s_add_u32 s76, s76, 1
    s_waitcnt vmcnt(0)
    v_cmp_ne_u32 vcc, 1, v29
    s_cmp_lt_u32 s76, 0x40000
    s_cbranch_scc0 L_pd_l
    s_cmp_eq_u64 vcc, 0
    s_cbranch_scc1 L_pd_l
    s_sleep 4
    buffer_load_dword v29, v26, s[24:27], s77 offen sc1
    s_branch L_pl_l
L_pd_l:
    ds_write_b32 v30, v31 offset:24
    s_branch L_l_go
L_l_np2:
    s_waitcnt vmcnt(0)
    ds_write_b32 v3, v31 offset:8
    s_mov_b32 s76, 0
L_sp_g5:
    ds_read_b32 v2, v30 offset:24
    s_add_u32 s76, s76, 1
    s_waitcnt lgkmcnt(0)
    v_readfirstlane_b32 s51, v2
    s_cmp_lt_u32 s76, 0x400000
    s_cbranch_scc0 L_spd_g5
    s_cmp_ge_u32 s51, 1
    s_cbranch_scc1 L_spd_g5
    s_sleep 1
    s_branch L_sp_g5
L_spd_g5:
L_l_go:
    buffer_load_dwordx4 v[144:147], v20, s[24:27], s60 offen sc1
    buffer_load_dwordx4 v[152:155], v20, s[24:27], s61 offen sc1
    buffer_load_dwordx4 v[160:163], v20, s[24:27], s62 offen sc1
    buffer_load_dwordx4 v[168:171], v20, s[24:27], s63 offen sc1
    buffer_load_dwordx4 v[176:179], v20, s[24:27], s64 offen sc1
    buffer_load_dwordx4 v[184:187], v20, s[24:27], s65 offen sc1
    buffer_load_dwordx4 v[192:195], v20, s[24:27], s66 offen sc1
    buffer_load_dwordx4 v[148:151], v21, s[24:27], s60 offen sc1
    buffer_load_dwordx4 v[156:159], v21, s[24:27], s61 offen sc1
    buffer_load_dwordx4 v[164:167], v21, s[24:27], s62 offen sc1
    buffer_load_dwordx4 v[172:175], v21, s[24:27], s63 offen sc1
    buffer_load_dwordx4 v[180:183], v21, s[24:27], s64 offen sc1
    buffer_load_dwordx4 v[188:191], v21, s[24:27], s65 offen sc1
    buffer_load_dwordx4 v[196:199], v21, s[24:27], s66 offen sc1
    s_waitcnt lgkmcnt(0)
    s_branch L_p2
L_compute:
    s_waitcnt lgkmcnt(0)
    v_mov_b32 v5, 155648
    v_mov_b32 v6, 0
    v_mov_b32 v7, 0
    v_mov_b32 v8, 0
    v_mov_b32 v9, 0
    ds_write_b128 v5, v[6:9]
    ds_write_b128 v5, v[6:9] offset:16
    s_cmp_ge_u32 s2, 224
    s_cbranch_scc1 L_c_idle
    s_setprio 2
    s_lshl_b32 s50, s40, 12
    s_lshl_b32 s51, s41, 7
    s_add_u32 s49, s50, s51
    s_add_u32 s49, s49, 0x400000
    s_cmp_lg_u32 s38, 1
    s_cbranch_scc1 L_c_noclear
    s_mov_b64 exec, 1
    buffer_store_dwordx4 v[6:9], off, s[24:27], s49 sc1
    s_mov_b64 exec, -1
L_c_noclear:
    s_and_b32 s50, s38, 1
    s_lshr_b32 s51, s38, 1
    v_and_b32 v2, 15, v1
    v_lshlrev_b32 v2, 7, v2
    s_lshl_b32 s52, s50, 13
    v_add_u32 v2, s52, v2
    v_lshrrev_b32 v3, 4, v1
    v_bfe_u32 v4, v1, 1, 3
    v_xor_b32 v4, v4, v3
    v_lshl_add_u32 v10, v4, 4, v2
    v_xor_b32 v11, 64, v10
    v_add_u32 v12, 0x10000, v10
    v_add_u32 v13, 0x10000, v11
    v_bfe_u32 v2, v1, 2, 2
    v_lshl_add_u32 v2, v3, 3, v2
    v_lshlrev_b32 v2, 7, v2
    v_and_b32 v5, 1, v1
    v_lshl_add_u32 v2, v5, 3, v2
    v_add_u32 v2, 16384, v2
    v_bfe_u32 v5, v1, 3, 2
    v_lshlrev_b32 v5, 1, v5
    v_bfe_u32 v6, v1, 1, 1
    s_lshl_b32 s52, s51, 2
    v_add_u32 v6, s52, v6
    v_xor_b32 v6, v6, v5
    v_lshl_add_u32 v14, v6, 4, v2
    v_xor_b32 v15, 32, v14
    v_add_u32 v16, 0x10000, v14
    v_add_u32 v17, 0x10000, v15
    s_lshl_b32 s52, s40, 1
    s_add_u32 s52, s52, s50
    s_mul_i32 s52, s52, 224
    s_lshl_b32 s53, s41, 1
    s_add_u32 s53, s53, s51
    s_add_u32 s52, s52, s53
    s_lshl_b32 s52, s52, 10
    v_lshlrev_b32 v18, 4, v1
    v_add_u32 v18, s52, v18
    s_mov_b32 s58, 0xbfb8aa3b
    s_mov_b32 s59, 0xbfb8aa3b
    s_mov_b32 s67, 57344
    s_mov_b32 s68, 114688
    s_mov_b32 s69, 172032
    s_lshl_b32 s74, s39, 13
    s_lshl_b32 s75, s39, 12
    s_add_u32 s75, s75, 131072
    s_bfe_u32 s50, s2, 0x20003
    s_and_b32 s51, s2, 1
    s_lshl_b32 s51, s51, 2
    s_add_u32 s44, s50, s51
    s_bfe_u32 s51, s2, 0x20001
    s_lshl_b32 s51, s51, 3
    s_lshr_b32 s52, s2, 5
    s_add_u32 s43, s51, s52
    s_mul_i32 s50, s50, 7
    s_lshr_b32 s50, s50, 2
    s_lshl_b32 s60, s50, 10
    s_add_u32 s61, s60, 1024
    s_cmp_eq_u32 s61, 7168
    s_cselect_b32 s61, 0, s61
    s_add_u32 s62, s61, 1024
    s_cmp_eq_u32 s62, 7168
    s_cselect_b32 s62, 0, s62
    s_add_u32 s63, s62, 1024
    s_cmp_eq_u32 s63, 7168
    s_cselect_b32 s63, 0, s63
    s_add_u32 s64, s63, 1024
    s_cmp_eq_u32 s64, 7168
    s_cselect_b32 s64, 0, s64
    s_add_u32 s65, s64, 1024
    s_cmp_eq_u32 s65, 7168
    s_cselect_b32 s65, 0, s65
    s_add_u32 s66, s65, 1024
    s_cmp_eq_u32 s66, 7168
    s_cselect_b32 s66, 0, s66
    v_lshrrev_b32 v2, 2, v1
    v_lshlrev_b32 v3, 7, v2
    v_and_b32 v4, 6, v2
    v_bfe_u32 v5, v1, 1, 1
    v_or_b32 v4, v4, v5
    v_lshl_add_u32 v3, v4, 4, v3
    v_and_b32 v4, 1, v1
    v_lshl_add_u32 v3, v4, 3, v3
    v_xor_b32 v4, 0, v3
    v_add_u32 v232, s74, v4
    v_add_u32 v236, 0x10000, v232
    v_add_u32 v240, s75, v4
    v_xor_b32 v4, 32, v3
    v_add_u32 v233, s74, v4
    v_add_u32 v237, 0x10000, v233
    v_add_u32 v241, s75, v4
    v_xor_b32 v4, 64, v3
    v_add_u32 v234, s74, v4
    v_add_u32 v238, 0x10000, v234
    v_add_u32 v242, s75, v4
    v_xor_b32 v4, 96, v3
    v_add_u32 v235, s74, v4
    v_add_u32 v239, 0x10000, v235
    v_add_u32 v243, s75, v4
    s_mul_i32 s50, s43, 112
    s_mov_b32 s70, s38
    s_mul_i32 s51, s70, 7
    s_add_u32 s50, s50, s51
    s_lshl_b32 s50, s50, 10
    v_lshlrev_b32 v20, 4, v1
    v_add_u32 v20, s50, v20
    v_add_u32 v21, 57344, v20
    v_and_b32 v3, 15, v1
    v_lshlrev_b32 v3, 8, v3
    s_add_u32 s50, s74, 0x18000
    v_add_u32 v3, s50, v3
    v_lshrrev_b32 v4, 4, v1
    v_and_b32 v5, 7, v1
    v_xor_b32 v4, v4, v5
    v_lshl_add_u32 v24, v4, 4, v3
    v_xor_b32 v25, 64, v24
    v_lshrrev_b32 v2, 4, v0
    v_and_b32 v3, 7, v2
    v_and_b32 v4, 15, v0
    v_xor_b32 v3, v3, v4
    v_lshlrev_b32 v3, 4, v3
    v_lshl_add_u32 v22, v2, 8, v3
    v_add_u32 v22, 0x10000, v22
    v_lshlrev_b32 v4, 3, v4
    v_lshl_add_u32 v23, v2, 10, v4
    s_lshl_b32 s50, s43, 15
    s_lshl_b32 s51, s44, 7
    s_add_u32 s50, s50, s51
    v_add_u32 v23, s50, v23
    s_lshr_b32 s50, s43, 2
    s_lshl_b32 s51, s50, 5
    v_mov_b32 v27, s51
    s_lshl_b32 s50, s50, 12
    s_mul_i32 s51, s38, 7
    s_lshr_b32 s51, s51, 1
    s_lshl_b32 s51, s51, 7
    s_add_u32 s77, s50, s51
    s_add_u32 s77, s77, 0x400000
    v_and_b32 v26, 3, v1
    v_lshlrev_b32 v26, 7, v26
    v_mov_b32 v30, 155648
    v_mov_b32 v31, 1
    s_cmp_lg_u32 s38, 1
    s_cbranch_scc1 L_c_nocount
    s_lshl_b32 s50, s40, 5
    v_mov_b32 v2, s50
    s_mov_b64 exec, 1
    s_waitcnt vmcnt(0)
    global_atomic_add v2, v31, s[36:37] sc1
    s_mov_b64 exec, -1
L_c_nocount:
    v_mov_b32 v96, 0
    v_mov_b32 v97, 0
    v_mov_b32 v98, 0
    v_mov_b32 v99, 0
    v_mov_b32 v100, 0
    v_mov_b32 v101, 0
    v_mov_b32 v102, 0
    v_mov_b32 v103, 0
    v_mov_b32 v104, 0
    v_mov_b32 v105, 0
    v_mov_b32 v106, 0
    v_mov_b32 v107, 0
    v_mov_b32 v108, 0
    v_mov_b32 v109, 0
    v_mov_b32 v110, 0
    v_mov_b32 v111, 0
    v_mov_b32 v112, 0
    v_mov_b32 v113, 0
    v_mov_b32 v114, 0
    v_mov_b32 v115, 0
    v_mov_b32 v116, 0
    v_mov_b32 v117, 0
    v_mov_b32 v118, 0
    v_mov_b32 v119, 0
    v_mov_b32 v120, 0
    v_mov_b32 v121, 0
    v_mov_b32 v122, 0
    v_mov_b32 v123, 0
    v_mov_b32 v124, 0
    v_mov_b32 v125, 0
    v_mov_b32 v126, 0
    v_mov_b32 v127, 0
    v_mov_b32 v128, 0
    v_mov_b32 v129, 0
    v_mov_b32 v130, 0
    v_mov_b32 v131, 0
    v_mov_b32 v132, 0
    v_mov_b32 v133, 0
    v_mov_b32 v134, 0
    v_mov_b32 v135, 0
    v_mov_b32 v136, 0
    v_mov_b32 v137, 0
    v_mov_b32 v138, 0
    v_mov_b32 v139, 0
    v_mov_b32 v140, 0
    v_mov_b32 v141, 0
    v_mov_b32 v142, 0
    v_mov_b32 v143, 0
    v_mov_b32 v144, 0
    v_mov_b32 v145, 0
    v_mov_b32 v146, 0
    v_mov_b32 v147, 0
    v_mov_b32 v148, 0
    v_mov_b32 v149, 0
    v_mov_b32 v150, 0
    v_mov_b32 v151, 0
    v_mov_b32 v152, 0
    v_mov_b32 v153, 0
    v_mov_b32 v154, 0
    v_mov_b32 v155, 0
    v_mov_b32 v156, 0
    v_mov_b32 v157, 0
    v_mov_b32 v158, 0
    v_mov_b32 v159, 0
    s_mov_b32 s47, 0x8000
    s_mov_b32 s48, 0x1ffff
    s_mov_b32 s42, 6
    s_waitcnt lgkmcnt(0)
    s_barrier
    ds_read_b64_tr_b16 v[32:33], v14 offset:0
    ds_read_b64_tr_b16 v[34:35], v14 offset:512
    ds_read_b64_tr_b16 v[36:37], v15 offset:0
    ds_read_b64_tr_b16 v[38:39], v15 offset:512
    ds_read_b64_tr_b16 v[40:41], v14 offset:8192
    ds_read_b64_tr_b16 v[42:43], v14 offset:8704
    ds_read_b64_tr_b16 v[44:45], v15 offset:8192
    ds_read_b64_tr_b16 v[46:47], v15 offset:8704
    ds_read_b128 v[48:51], v10 offset:0
    ds_read_b128 v[52:55], v10 offset:2048
    ds_read_b128 v[56:59], v10 offset:4096
    ds_read_b128 v[60:63], v10 offset:6144
L_main:
    s_waitcnt lgkmcnt(3)
    v_mfma_f32_16x16x32_bf16 v[96:99], v[32:35], v[48:51], v[96:99]
    ds_read_b64_tr_b16 v[64:65], v14 offset:4096
    v_mfma_f32_16x16x32_bf16 v[100:103], v[36:39], v[48:51], v[100:103]
    ds_read_b64_tr_b16 v[66:67], v14 offset:4608
    v_mfma_f32_16x16x32_bf16 v[104:107], v[40:43], v[48:51], v[104:107]
    ds_read_b64_tr_b16 v[68:69], v15 offset:4096
    v_mfma_f32_16x16x32_bf16 v[108:111], v[44:47], v[48:51], v[108:111]
    ds_read_b64_tr_b16 v[70:71], v15 offset:4608
    s_waitcnt lgkmcnt(6)
    v_mfma_f32_16x16x32_bf16 v[112:115], v[32:35], v[52:55], v[112:115]
    ds_read_b64_tr_b16 v[72:73], v14 offset:12288
    v_mfma_f32_16x16x32_bf16 v[116:119], v[36:39], v[52:55], v[116:119]
    ds_read_b64_tr_b16 v[74:75], v14 offset:12800
    v_mfma_f32_16x16x32_bf16 v[120:123], v[40:43], v[52:55], v[120:123]
    ds_read_b64_tr_b16 v[76:77], v15 offset:12288
    v_mfma_f32_16x16x32_bf16 v[124:127], v[44:47], v[52:55], v[124:127]
    ds_read_b64_tr_b16 v[78:79], v15 offset:12800
    s_waitcnt lgkmcnt(9)
    v_mfma_f32_16x16x32_bf16 v[128:131], v[32:35], v[56:59], v[128:131]
    ds_read_b128 v[80:83], v11 offset:0
    v_mfma_f32_16x16x32_bf16 v[132:135], v[36:39], v[56:59], v[132:135]
    ds_read_b128 v[84:87], v11 offset:2048
    v_mfma_f32_16x16x32_bf16 v[136:139], v[40:43], v[56:59], v[136:139]
    ds_read_b128 v[88:91], v11 offset:4096
    v_mfma_f32_16x16x32_bf16 v[140:143], v[44:47], v[56:59], v[140:143]
    ds_read_b128 v[92:95], v11 offset:6144
    s_waitcnt lgkmcnt(12)
    v_mfma_f32_16x16x32_bf16 v[144:147], v[32:35], v[60:63], v[144:147]
    v_add_u32 v14, s47, v14
    v_and_b32 v14, s48, v14
    v_mfma_f32_16x16x32_bf16 v[148:151], v[36:39], v[60:63], v[148:151]
    v_add_u32 v15, s47, v15
    v_and_b32 v15, s48, v15
    v_mfma_f32_16x16x32_bf16 v[152:155], v[40:43], v[60:63], v[152:155]
    v_add_u32 v10, s47, v10
    v_and_b32 v10, s48, v10
    v_mfma_f32_16x16x32_bf16 v[156:159], v[44:47], v[60:63], v[156:159]
    v_add_u32 v11, s47, v11
    v_and_b32 v11, s48, v11
    s_waitcnt lgkmcnt(0)
    s_barrier
    v_mfma_f32_16x16x32_bf16 v[96:99], v[64:67], v[80:83], v[96:99]
    ds_read_b64_tr_b16 v[32:33], v14 offset:0
    v_mfma_f32_16x16x32_bf16 v[100:103], v[68:71], v[80:83], v[100:103]
    ds_read_b64_tr_b16 v[34:35], v14 offset:512
    v_mfma_f32_16x16x32_bf16 v[104:107], v[72:75], v[80:83], v[104:107]
    ds_read_b64_tr_b16 v[36:37], v15 offset:0
    v_mfma_f32_16x16x32_bf16 v[108:111], v[76:79], v[80:83], v[108:111]
    ds_read_b64_tr_b16 v[38:39], v15 offset:512
    v_mfma_f32_16x16x32_bf16 v[112:115], v[64:67], v[84:87], v[112:115]
    ds_read_b64_tr_b16 v[40:41], v14 offset:8192
    v_mfma_f32_16x16x32_bf16 v[116:119], v[68:71], v[84:87], v[116:119]
    ds_read_b64_tr_b16 v[42:43], v14 offset:8704
    v_mfma_f32_16x16x32_bf16 v[120:123], v[72:75], v[84:87], v[120:123]
    ds_read_b64_tr_b16 v[44:45], v15 offset:8192
    v_mfma_f32_16x16x32_bf16 v[124:127], v[76:79], v[84:87], v[124:127]
    ds_read_b64_tr_b16 v[46:47], v15 offset:8704
    v_mfma_f32_16x16x32_bf16 v[128:131], v[64:67], v[88:91], v[128:131]
    ds_read_b128 v[48:51], v10 offset:0
    v_mfma_f32_16x16x32_bf16 v[132:135], v[68:71], v[88:91], v[132:135]
    ds_read_b128 v[52:55], v10 offset:2048
    v_mfma_f32_16x16x32_bf16 v[136:139], v[72:75], v[88:91], v[136:139]
    ds_read_b128 v[56:59], v10 offset:4096
    v_mfma_f32_16x16x32_bf16 v[140:143], v[76:79], v[88:91], v[140:143]
    ds_read_b128 v[60:63], v10 offset:6144
    v_mfma_f32_16x16x32_bf16 v[144:147], v[64:67], v[92:95], v[144:147]
    s_sub_u32 s42, s42, 1
    s_cmp_lg_u32 s42, 0
    v_mfma_f32_16x16x32_bf16 v[148:151], v[68:71], v[92:95], v[148:151]
    v_mfma_f32_16x16x32_bf16 v[152:155], v[72:75], v[92:95], v[152:155]
    v_mfma_f32_16x16x32_bf16 v[156:159], v[76:79], v[92:95], v[156:159]
    s_cbranch_scc1 L_main
    s_waitcnt lgkmcnt(3)
    v_mfma_f32_16x16x32_bf16 v[96:99], v[32:35], v[48:51], v[96:99]
    ds_read_b64_tr_b16 v[64:65], v16 offset:4096
    v_mfma_f32_16x16x32_bf16 v[100:103], v[36:39], v[48:51], v[100:103]
    ds_read_b64_tr_b16 v[66:67], v16 offset:4608
    v_mfma_f32_16x16x32_bf16 v[104:107], v[40:43], v[48:51], v[104:107]
    ds_read_b64_tr_b16 v[68:69], v17 offset:4096
    v_mfma_f32_16x16x32_bf16 v[108:111], v[44:47], v[48:51], v[108:111]
    ds_read_b64_tr_b16 v[70:71], v17 offset:4608
    s_waitcnt lgkmcnt(6)
    v_mfma_f32_16x16x32_bf16 v[112:115], v[32:35], v[52:55], v[112:115]
    ds_read_b64_tr_b16 v[72:73], v16 offset:12288
    v_mfma_f32_16x16x32_bf16 v[116:119], v[36:39], v[52:55], v[116:119]
    ds_read_b64_tr_b16 v[74:75], v16 offset:12800
    v_mfma_f32_16x16x32_bf16 v[120:123], v[40:43], v[52:55], v[120:123]
    ds_read_b64_tr_b16 v[76:77], v17 offset:12288
    v_mfma_f32_16x16x32_bf16 v[124:127], v[44:47], v[52:55], v[124:127]
    ds_read_b64_tr_b16 v[78:79], v17 offset:12800
    s_waitcnt lgkmcnt(9)
    v_mfma_f32_16x16x32_bf16 v[128:131], v[32:35], v[56:59], v[128:131]
    ds_read_b128 v[80:83], v13 offset:0
    v_mfma_f32_16x16x32_bf16 v[132:135], v[36:39], v[56:59], v[132:135]
    ds_read_b128 v[84:87], v13 offset:2048
    v_mfma_f32_16x16x32_bf16 v[136:139], v[40:43], v[56:59], v[136:139]
    ds_read_b128 v[88:91], v13 offset:4096
    v_mfma_f32_16x16x32_bf16 v[140:143], v[44:47], v[56:59], v[140:143]
    ds_read_b128 v[92:95], v13 offset:6144
    s_waitcnt lgkmcnt(12)
    v_mfma_f32_16x16x32_bf16 v[144:147], v[32:35], v[60:63], v[144:147]
    v_mfma_f32_16x16x32_bf16 v[148:151], v[36:39], v[60:63], v[148:151]
    v_mfma_f32_16x16x32_bf16 v[152:155], v[40:43], v[60:63], v[152:155]
    v_mfma_f32_16x16x32_bf16 v[156:159], v[44:47], v[60:63], v[156:159]
    s_waitcnt lgkmcnt(0)
    s_barrier
    v_mfma_f32_16x16x32_bf16 v[96:99], v[64:67], v[80:83], v[96:99]
    ds_read_b64_tr_b16 v[32:33], v16 offset:32768
    v_mfma_f32_16x16x32_bf16 v[100:103], v[68:71], v[80:83], v[100:103]
    ds_read_b64_tr_b16 v[34:35], v16 offset:33280
    v_mfma_f32_16x16x32_bf16 v[104:107], v[72:75], v[80:83], v[104:107]
    ds_read_b64_tr_b16 v[36:37], v17 offset:32768
    v_mfma_f32_16x16x32_bf16 v[108:111], v[76:79], v[80:83], v[108:111]
    ds_read_b64_tr_b16 v[38:39], v17 offset:33280
    v_mfma_f32_16x16x32_bf16 v[112:115], v[64:67], v[84:87], v[112:115]
    ds_read_b64_tr_b16 v[40:41], v16 offset:40960
    v_mfma_f32_16x16x32_bf16 v[116:119], v[68:71], v[84:87], v[116:119]
    ds_read_b64_tr_b16 v[42:43], v16 offset:41472
    v_mfma_f32_16x16x32_bf16 v[120:123], v[72:75], v[84:87], v[120:123]
    ds_read_b64_tr_b16 v[44:45], v17 offset:40960
    v_mfma_f32_16x16x32_bf16 v[124:127], v[76:79], v[84:87], v[124:127]
    ds_read_b64_tr_b16 v[46:47], v17 offset:41472
    v_mfma_f32_16x16x32_bf16 v[128:131], v[64:67], v[88:91], v[128:131]
    ds_read_b128 v[160:163], v12 offset:32768
    v_mfma_f32_16x16x32_bf16 v[132:135], v[68:71], v[88:91], v[132:135]
    ds_read_b64_tr_b16 v[48:49], v16 offset:36864
    v_mfma_f32_16x16x32_bf16 v[136:139], v[72:75], v[88:91], v[136:139]
    ds_read_b64_tr_b16 v[50:51], v16 offset:37376
    v_mfma_f32_16x16x32_bf16 v[140:143], v[76:79], v[88:91], v[140:143]
    ds_read_b64_tr_b16 v[52:53], v17 offset:36864
    v_mfma_f32_16x16x32_bf16 v[144:147], v[64:67], v[92:95], v[144:147]
    s_waitcnt lgkmcnt(8)
    ds_read_b64_tr_b16 v[54:55], v17 offset:37376
    v_mfma_f32_16x16x32_bf16 v[148:151], v[68:71], v[92:95], v[148:151]
    ds_read_b64_tr_b16 v[56:57], v16 offset:45056
    v_mfma_f32_16x16x32_bf16 v[152:155], v[72:75], v[92:95], v[152:155]
    ds_read_b64_tr_b16 v[58:59], v16 offset:45568
    v_mfma_f32_16x16x32_bf16 v[156:159], v[76:79], v[92:95], v[156:159]
    ds_read_b64_tr_b16 v[60:61], v17 offset:45056
    s_waitcnt lgkmcnt(7)
    v_mfma_f32_16x16x32_bf16 v[96:99], v[32:35], v[160:163], v[96:99]
    ds_read_b64_tr_b16 v[62:63], v17 offset:45568
    v_mfma_f32_16x16x32_bf16 v[100:103], v[36:39], v[160:163], v[100:103]
    ds_read_b128 v[164:167], v13 offset:32768
    v_mfma_f32_16x16x32_bf16 v[104:107], v[40:43], v[160:163], v[104:107]
    ds_read_b128 v[168:171], v12 offset:34816
    v_mfma_f32_16x16x32_bf16 v[108:111], v[44:47], v[160:163], v[108:111]
    ds_read_b128 v[172:175], v13 offset:34816
    s_waitcnt lgkmcnt(2)
    v_mfma_f32_16x16x32_bf16 v[96:99], v[48:51], v[164:167], v[96:99]
    ds_read_b128 v[176:179], v12 offset:36864
    v_mfma_f32_16x16x32_bf16 v[100:103], v[52:55], v[164:167], v[100:103]
    ds_read_b128 v[180:183], v13 offset:36864
    v_mfma_f32_16x16x32_bf16 v[104:107], v[56:59], v[164:167], v[104:107]
    ds_read_b128 v[184:187], v12 offset:38912
    v_mfma_f32_16x16x32_bf16 v[108:111], v[60:63], v[164:167], v[108:111]
    ds_read_b128 v[188:191], v13 offset:38912
    s_waitcnt lgkmcnt(4)
    v_mfma_f32_16x16x32_bf16 v[112:115], v[32:35], v[168:171], v[112:115]
    v_mul_f32 v192, s58, v96
    v_mul_f32 v193, s58, v97
    v_mfma_f32_16x16x32_bf16 v[116:119], v[36:39], v[168:171], v[116:119]
    v_mul_f32 v194, s58, v98
    v_mul_f32 v195, s58, v99
    v_mfma_f32_16x16x32_bf16 v[120:123], v[40:43], v[168:171], v[120:123]
    v_mul_f32 v196, s58, v100
    v_mul_f32 v197, s58, v101
    v_mfma_f32_16x16x32_bf16 v[124:127], v[44:47], v[168:171], v[124:127]
    v_mul_f32 v198, s58, v102
    v_mul_f32 v199, s58, v103
    v_mfma_f32_16x16x32_bf16 v[112:115], v[48:51], v[172:175], v[112:115]
    v_exp_f32 v192, v192
    v_mfma_f32_16x16x32_bf16 v[116:119], v[52:55], v[172:175], v[116:119]
    v_mul_f32 v96, v96, v104
    v_mfma_f32_16x16x32_bf16 v[120:123], v[56:59], v[172:175], v[120:123]
    v_exp_f32 v193, v193
    v_mfma_f32_16x16x32_bf16 v[124:127], v[60:63], v[172:175], v[124:127]
    v_mul_f32 v97, v97, v105
    s_waitcnt lgkmcnt(0)
    ds_add_u32 v30, v31 offset:4
    v_mfma_f32_16x16x32_bf16 v[128:131], v[32:35], v[176:179], v[128:131]
    v_exp_f32 v194, v194
    v_mfma_f32_16x16x32_bf16 v[132:135], v[36:39], v[176:179], v[132:135]
    v_mul_f32 v98, v98, v106
    v_mfma_f32_16x16x32_bf16 v[136:139], v[40:43], v[176:179], v[136:139]
    v_exp_f32 v195, v195
    v_mfma_f32_16x16x32_bf16 v[140:143], v[44:47], v[176:179], v[140:143]
    v_mul_f32 v99, v99, v107
    v_mfma_f32_16x16x32_bf16 v[128:131], v[48:51], v[180:183], v[128:131]
    v_exp_f32 v196, v196
    v_mfma_f32_16x16x32_bf16 v[132:135], v[52:55], v[180:183], v[132:135]
    v_mul_f32 v100, v100, v108
    v_mfma_f32_16x16x32_bf16 v[136:139], v[56:59], v[180:183], v[136:139]
    v_exp_f32 v197, v197
    v_mfma_f32_16x16x32_bf16 v[140:143], v[60:63], v[180:183], v[140:143]
    v_mul_f32 v101, v101, v109
    v_mfma_f32_16x16x32_bf16 v[144:147], v[32:35], v[184:187], v[144:147]
    v_exp_f32 v198, v198
    v_mfma_f32_16x16x32_bf16 v[148:151], v[36:39], v[184:187], v[148:151]
    v_mul_f32 v102, v102, v110
    v_mfma_f32_16x16x32_bf16 v[152:155], v[40:43], v[184:187], v[152:155]
    v_exp_f32 v199, v199
    v_mfma_f32_16x16x32_bf16 v[156:159], v[44:47], v[184:187], v[156:159]
    v_mul_f32 v103, v103, v111
    v_add_f32 v192, 1.0, v192
    v_mfma_f32_16x16x32_bf16 v[144:147], v[48:51], v[188:191], v[144:147]
    v_add_f32 v193, 1.0, v193
    v_add_f32 v194, 1.0, v194
    v_mfma_f32_16x16x32_bf16 v[148:151], v[52:55], v[188:191], v[148:151]
    v_add_f32 v195, 1.0, v195
    v_add_f32 v196, 1.0, v196
    v_mfma_f32_16x16x32_bf16 v[152:155], v[56:59], v[188:191], v[152:155]
    v_add_f32 v197, 1.0, v197
    v_add_f32 v198, 1.0, v198
    v_mfma_f32_16x16x32_bf16 v[156:159], v[60:63], v[188:191], v[156:159]
    v_add_f32 v199, 1.0, v199
    v_rcp_f32 v192, v192
    v_rcp_f32 v193, v193
    v_rcp_f32 v194, v194
    v_rcp_f32 v195, v195
    v_rcp_f32 v196, v196
    v_rcp_f32 v197, v197
    v_rcp_f32 v198, v198
    v_rcp_f32 v199, v199
    v_mul_f32 v96, v96, v192
    v_mul_f32 v97, v97, v193
    v_mul_f32 v98, v98, v194
    v_mul_f32 v99, v99, v195
    v_mul_f32 v100, v100, v196
    v_mul_f32 v101, v101, v197
    v_mul_f32 v102, v102, v198
    v_mul_f32 v103, v103, v199
    v_cvt_pk_bf16_f32 v200, v96, v97
    v_cvt_pk_bf16_f32 v201, v98, v99
    v_cvt_pk_bf16_f32 v202, v100, v101
    v_cvt_pk_bf16_f32 v203, v102, v103
    buffer_store_dwordx4 v[200:203], v18, s[24:27], 0 offen sc1
    v_mul_f32 v208, s58, v112
    v_mul_f32 v209, s58, v113
    v_mul_f32 v210, s58, v114
    v_mul_f32 v211, s58, v115
    v_mul_f32 v212, s58, v116
    v_mul_f32 v213, s58, v117
    v_mul_f32 v214, s58, v118
    v_mul_f32 v215, s58, v119
    v_exp_f32 v208, v208
    v_mul_f32 v112, v112, v120
    v_exp_f32 v209, v209
    v_mul_f32 v113, v113, v121
    v_exp_f32 v210, v210
    v_mul_f32 v114, v114, v122
    v_exp_f32 v211, v211
    v_mul_f32 v115, v115, v123
    v_exp_f32 v212, v212
    v_mul_f32 v116, v116, v124
    v_exp_f32 v213, v213
    v_mul_f32 v117, v117, v125
    v_exp_f32 v214, v214
    v_mul_f32 v118, v118, v126
    v_exp_f32 v215, v215
    v_mul_f32 v119, v119, v127
    v_add_f32 v208, 1.0, v208
    v_add_f32 v209, 1.0, v209
    v_add_f32 v210, 1.0, v210
    v_add_f32 v211, 1.0, v211
    v_add_f32 v212, 1.0, v212
    v_add_f32 v213, 1.0, v213
    v_add_f32 v214, 1.0, v214
    v_add_f32 v215, 1.0, v215
    v_rcp_f32 v208, v208
    v_rcp_f32 v209, v209
    v_rcp_f32 v210, v210
    v_rcp_f32 v211, v211
    v_rcp_f32 v212, v212
    v_rcp_f32 v213, v213
    v_rcp_f32 v214, v214
    v_rcp_f32 v215, v215
    v_mul_f32 v112, v112, v208
    v_mul_f32 v113, v113, v209
    v_mul_f32 v114, v114, v210
    v_mul_f32 v115, v115, v211
    v_mul_f32 v116, v116, v212
    v_mul_f32 v117, v117, v213
    v_mul_f32 v118, v118, v214
    v_mul_f32 v119, v119, v215
    v_cvt_pk_bf16_f32 v216, v112, v113
    v_cvt_pk_bf16_f32 v217, v114, v115
    v_cvt_pk_bf16_f32 v218, v116, v117
    v_cvt_pk_bf16_f32 v219, v118, v119
    buffer_store_dwordx4 v[216:219], v18, s[24:27], s67 offen sc1
    v_mul_f32 v192, s58, v128
    v_mul_f32 v193, s58, v129
    v_mul_f32 v194, s58, v130
    v_mul_f32 v195, s58, v131
    v_mul_f32 v196, s58, v132
    v_mul_f32 v197, s58, v133
    v_mul_f32 v198, s58, v134
    v_mul_f32 v199, s58, v135
    v_exp_f32 v192, v192
    v_mul_f32 v128, v128, v136
    v_exp_f32 v193, v193
    v_mul_f32 v129, v129, v137
    v_exp_f32 v194, v194
    v_mul_f32 v130, v130, v138
    v_exp_f32 v195, v195
    v_mul_f32 v131, v131, v139
    v_exp_f32 v196, v196
    v_mul_f32 v132, v132, v140
    v_exp_f32 v197, v197
    v_mul_f32 v133, v133, v141
    v_exp_f32 v198, v198
    v_mul_f32 v134, v134, v142
    v_exp_f32 v199, v199
    v_mul_f32 v135, v135, v143
    v_add_f32 v192, 1.0, v192
    v_add_f32 v193, 1.0, v193
    v_add_f32 v194, 1.0, v194
    v_add_f32 v195, 1.0, v195
    v_add_f32 v196, 1.0, v196
    v_add_f32 v197, 1.0, v197
    v_add_f32 v198, 1.0, v198
    v_add_f32 v199, 1.0, v199
    v_rcp_f32 v192, v192
    v_rcp_f32 v193, v193
    v_rcp_f32 v194, v194
    v_rcp_f32 v195, v195
    v_rcp_f32 v196, v196
    v_rcp_f32 v197, v197
    v_rcp_f32 v198, v198
    v_rcp_f32 v199, v199
    v_mul_f32 v128, v128, v192
    v_mul_f32 v129, v129, v193
    v_mul_f32 v130, v130, v194
    v_mul_f32 v131, v131, v195
    v_mul_f32 v132, v132, v196
    v_mul_f32 v133, v133, v197
    v_mul_f32 v134, v134, v198
    v_mul_f32 v135, v135, v199
    v_cvt_pk_bf16_f32 v200, v128, v129
    v_cvt_pk_bf16_f32 v201, v130, v131
    v_cvt_pk_bf16_f32 v202, v132, v133
    v_cvt_pk_bf16_f32 v203, v134, v135
    buffer_store_dwordx4 v[200:203], v18, s[24:27], s68 offen sc1
    v_mul_f32 v208, s58, v144
    v_mul_f32 v209, s58, v145
    v_mul_f32 v210, s58, v146
    v_mul_f32 v211, s58, v147
    v_mul_f32 v212, s58, v148
    v_mul_f32 v213, s58, v149
    v_mul_f32 v214, s58, v150
    v_mul_f32 v215, s58, v151
    v_exp_f32 v208, v208
    v_mul_f32 v144, v144, v152
    v_exp_f32 v209, v209
    v_mul_f32 v145, v145, v153
    v_exp_f32 v210, v210
    v_mul_f32 v146, v146, v154
    v_exp_f32 v211, v211
    v_mul_f32 v147, v147, v155
    v_exp_f32 v212, v212
    v_mul_f32 v148, v148, v156
    v_exp_f32 v213, v213
    v_mul_f32 v149, v149, v157
    v_exp_f32 v214, v214
    v_mul_f32 v150, v150, v158
    v_exp_f32 v215, v215
    v_mul_f32 v151, v151, v159
    v_add_f32 v208, 1.0, v208
    v_add_f32 v209, 1.0, v209
    v_add_f32 v210, 1.0, v210
    v_add_f32 v211, 1.0, v211
    v_add_f32 v212, 1.0, v212
    v_add_f32 v213, 1.0, v213
    v_add_f32 v214, 1.0, v214
    v_add_f32 v215, 1.0, v215
    v_rcp_f32 v208, v208
    v_rcp_f32 v209, v209
    v_rcp_f32 v210, v210
    v_rcp_f32 v211, v211
    v_rcp_f32 v212, v212
    v_rcp_f32 v213, v213
    v_rcp_f32 v214, v214
    v_rcp_f32 v215, v215
    v_mul_f32 v144, v144, v208
    v_mul_f32 v145, v145, v209
    v_mul_f32 v146, v146, v210
    v_mul_f32 v147, v147, v211
    v_mul_f32 v148, v148, v212
    v_mul_f32 v149, v149, v213
    v_mul_f32 v150, v150, v214
    v_mul_f32 v151, v151, v215
    v_cvt_pk_bf16_f32 v216, v144, v145
    v_cvt_pk_bf16_f32 v217, v146, v147
    v_cvt_pk_bf16_f32 v218, v148, v149
    v_cvt_pk_bf16_f32 v219, v150, v151
    buffer_store_dwordx4 v[216:219], v18, s[24:27], s69 offen sc1
    s_waitcnt vmcnt(0)
    s_mov_b64 exec, 1
    ds_add_rtn_u32 v2, v30, v31
    s_waitcnt lgkmcnt(0)
    v_readfirstlane_b32 s51, v2
    s_nop 3
    s_cmp_eq_u32 s51, 3
    s_cbranch_scc0 L_c_noflag
    buffer_store_dword v31, off, s[24:27], s49 sc1
L_c_noflag:
    s_mov_b64 exec, -1
    s_setprio 0
    s_branch L_c_join
L_c_idle:
    s_lshl_b32 s74, s39, 13
    s_lshl_b32 s75, s39, 12
    s_add_u32 s75, s75, 131072
    s_bfe_u32 s50, s2, 0x20003
    s_and_b32 s51, s2, 1
    s_lshl_b32 s51, s51, 2
    s_add_u32 s44, s50, s51
    s_bfe_u32 s51, s2, 0x20001
    s_lshl_b32 s51, s51, 3
    s_lshr_b32 s52, s2, 5
    s_add_u32 s43, s51, s52
    s_mul_i32 s50, s50, 7
    s_lshr_b32 s50, s50, 2
    s_lshl_b32 s60, s50, 10
    s_add_u32 s61, s60, 1024
    s_cmp_eq_u32 s61, 7168
    s_cselect_b32 s61, 0, s61
    s_add_u32 s62, s61, 1024
    s_cmp_eq_u32 s62, 7168
    s_cselect_b32 s62, 0, s62
    s_add_u32 s63, s62, 1024
    s_cmp_eq_u32 s63, 7168
    s_cselect_b32 s63, 0, s63
    s_add_u32 s64, s63, 1024
    s_cmp_eq_u32 s64, 7168
    s_cselect_b32 s64, 0, s64
    s_add_u32 s65, s64, 1024
    s_cmp_eq_u32 s65, 7168
    s_cselect_b32 s65, 0, s65
    s_add_u32 s66, s65, 1024
    s_cmp_eq_u32 s66, 7168
    s_cselect_b32 s66, 0, s66
    v_lshrrev_b32 v2, 2, v1
    v_lshlrev_b32 v3, 7, v2
    v_and_b32 v4, 6, v2
    v_bfe_u32 v5, v1, 1, 1
    v_or_b32 v4, v4, v5
    v_lshl_add_u32 v3, v4, 4, v3
    v_and_b32 v4, 1, v1
    v_lshl_add_u32 v3, v4, 3, v3
    v_xor_b32 v4, 0, v3
    v_add_u32 v232, s74, v4
    v_add_u32 v236, 0x10000, v232
    v_add_u32 v240, s75, v4
    v_xor_b32 v4, 32, v3
    v_add_u32 v233, s74, v4
    v_add_u32 v237, 0x10000, v233
    v_add_u32 v241, s75, v4
    v_xor_b32 v4, 64, v3
    v_add_u32 v234, s74, v4
    v_add_u32 v238, 0x10000, v234
    v_add_u32 v242, s75, v4
    v_xor_b32 v4, 96, v3
    v_add_u32 v235, s74, v4
    v_add_u32 v239, 0x10000, v235
    v_add_u32 v243, s75, v4
    s_mul_i32 s50, s43, 112
    s_mov_b32 s70, s38
    s_mul_i32 s51, s70, 7
    s_add_u32 s50, s50, s51
    s_lshl_b32 s50, s50, 10
    v_lshlrev_b32 v20, 4, v1
    v_add_u32 v20, s50, v20
    v_add_u32 v21, 57344, v20
    v_and_b32 v3, 15, v1
    v_lshlrev_b32 v3, 8, v3
    s_add_u32 s50, s74, 0x18000
    v_add_u32 v3, s50, v3
    v_lshrrev_b32 v4, 4, v1
    v_and_b32 v5, 7, v1
    v_xor_b32 v4, v4, v5
    v_lshl_add_u32 v24, v4, 4, v3
    v_xor_b32 v25, 64, v24
    v_lshrrev_b32 v2, 4, v0
    v_and_b32 v3, 7, v2
    v_and_b32 v4, 15, v0
    v_xor_b32 v3, v3, v4
    v_lshlrev_b32 v3, 4, v3
    v_lshl_add_u32 v22, v2, 8, v3
    v_add_u32 v22, 0x10000, v22
    v_lshlrev_b32 v4, 3, v4
    v_lshl_add_u32 v23, v2, 10, v4
    s_lshl_b32 s50, s43, 15
    s_lshl_b32 s51, s44, 7
    s_add_u32 s50, s50, s51
    v_add_u32 v23, s50, v23
    s_lshr_b32 s50, s43, 2
    s_lshl_b32 s51, s50, 5
    v_mov_b32 v27, s51
    s_lshl_b32 s50, s50, 12
    s_mul_i32 s51, s38, 7
    s_lshr_b32 s51, s51, 1
    s_lshl_b32 s51, s51, 7
    s_add_u32 s77, s50, s51
    s_add_u32 s77, s77, 0x400000
    v_and_b32 v26, 3, v1
    v_lshlrev_b32 v26, 7, v26
    v_mov_b32 v30, 155648
    v_mov_b32 v31, 1
    s_waitcnt lgkmcnt(0)
    s_barrier
L_c_join:
    s_lshl_b32 s50, s39, 2
    v_add_u32 v3, s50, v30
    s_mov_b32 s76, 0
L_sp_pc:
    ds_read_b32 v2, v3 offset:8
    s_add_u32 s76, s76, 1
    s_waitcnt lgkmcnt(0)
    v_readfirstlane_b32 s51, v2
    s_cmp_lt_u32 s76, 0x400000
    s_cbranch_scc0 L_spd_pc
    s_cmp_ge_u32 s51, 1
    s_cbranch_scc1 L_spd_pc
    s_sleep 1
    s_branch L_sp_pc
L_spd_pc:
    s_mov_b32 s76, 0
L_sp_pd:
    ds_read_b32 v2, v30 offset:24
    s_add_u32 s76, s76, 1
    s_waitcnt lgkmcnt(0)
    v_readfirstlane_b32 s51, v2
    s_cmp_lt_u32 s76, 0x400000
    s_cbranch_scc0 L_spd_pd
    s_cmp_ge_u32 s51, 1
    s_cbranch_scc1 L_spd_pd
    s_sleep 1
    s_branch L_sp_pd
L_spd_pd:
    buffer_load_dwordx4 v[144:147], v20, s[24:27], s60 offen sc1
    buffer_load_dwordx4 v[152:155], v20, s[24:27], s61 offen sc1
    buffer_load_dwordx4 v[160:163], v20, s[24:27], s62 offen sc1
    buffer_load_dwordx4 v[168:171], v20, s[24:27], s63 offen sc1
    buffer_load_dwordx4 v[176:179], v20, s[24:27], s64 offen sc1
    buffer_load_dwordx4 v[184:187], v20, s[24:27], s65 offen sc1
    buffer_load_dwordx4 v[192:195], v20, s[24:27], s66 offen sc1
    buffer_load_dwordx4 v[148:151], v21, s[24:27], s60 offen sc1
    buffer_load_dwordx4 v[156:159], v21, s[24:27], s61 offen sc1
    buffer_load_dwordx4 v[164:167], v21, s[24:27], s62 offen sc1
    buffer_load_dwordx4 v[172:175], v21, s[24:27], s63 offen sc1
    buffer_load_dwordx4 v[180:183], v21, s[24:27], s64 offen sc1
    buffer_load_dwordx4 v[188:191], v21, s[24:27], s65 offen sc1
    buffer_load_dwordx4 v[196:199], v21, s[24:27], s66 offen sc1
    ds_read_b64_tr_b16 v[32:33], v236 offset:32768
    ds_read_b64_tr_b16 v[34:35], v236 offset:34816
    ds_read_b64_tr_b16 v[36:37], v237 offset:32768
    ds_read_b64_tr_b16 v[38:39], v237 offset:34816
    ds_read_b64_tr_b16 v[40:41], v238 offset:32768
    ds_read_b64_tr_b16 v[42:43], v238 offset:34816
    ds_read_b64_tr_b16 v[44:45], v239 offset:32768
    ds_read_b64_tr_b16 v[46:47], v239 offset:34816
    s_waitcnt lgkmcnt(4)
    ds_read_b64_tr_b16 v[48:49], v236 offset:36864
    ds_read_b64_tr_b16 v[50:51], v236 offset:38912
    ds_read_b64_tr_b16 v[52:53], v237 offset:36864
    ds_read_b64_tr_b16 v[54:55], v237 offset:38912
    ds_read_b64_tr_b16 v[56:57], v238 offset:36864
    ds_read_b64_tr_b16 v[58:59], v238 offset:38912
    ds_read_b64_tr_b16 v[60:61], v239 offset:36864
    ds_read_b64_tr_b16 v[62:63], v239 offset:38912
    s_waitcnt lgkmcnt(4)
    ds_read_b64_tr_b16 v[64:65], v240 offset:0
    ds_read_b64_tr_b16 v[66:67], v240 offset:2048
    ds_read_b64_tr_b16 v[68:69], v241 offset:0
    ds_read_b64_tr_b16 v[70:71], v241 offset:2048
    ds_read_b64_tr_b16 v[72:73], v242 offset:0
    ds_read_b64_tr_b16 v[74:75], v242 offset:2048
    ds_read_b64_tr_b16 v[76:77], v243 offset:0
    ds_read_b64_tr_b16 v[78:79], v243 offset:2048
    s_waitcnt lgkmcnt(4)
    ds_read_b64_tr_b16 v[80:81], v232 offset:0
    ds_read_b64_tr_b16 v[82:83], v232 offset:2048
    ds_read_b64_tr_b16 v[84:85], v233 offset:0
    ds_read_b64_tr_b16 v[86:87], v233 offset:2048
    ds_read_b64_tr_b16 v[88:89], v234 offset:0
    ds_read_b64_tr_b16 v[90:91], v234 offset:2048
    ds_read_b64_tr_b16 v[92:93], v235 offset:0
    ds_read_b64_tr_b16 v[94:95], v235 offset:2048
    s_waitcnt lgkmcnt(4)
    ds_read_b64_tr_b16 v[96:97], v232 offset:4096
    ds_read_b64_tr_b16 v[98:99], v232 offset:6144
    ds_read_b64_tr_b16 v[100:101], v233 offset:4096
    ds_read_b64_tr_b16 v[102:103], v233 offset:6144
    ds_read_b64_tr_b16 v[104:105], v234 offset:4096
    ds_read_b64_tr_b16 v[106:107], v234 offset:6144
    ds_read_b64_tr_b16 v[108:109], v235 offset:4096
    ds_read_b64_tr_b16 v[110:111], v235 offset:6144
    s_waitcnt lgkmcnt(4)
    ds_read_b64_tr_b16 v[112:113], v232 offset:32768
    ds_read_b64_tr_b16 v[114:115], v232 offset:34816
    ds_read_b64_tr_b16 v[116:117], v233 offset:32768
    ds_read_b64_tr_b16 v[118:119], v233 offset:34816
    ds_read_b64_tr_b16 v[120:121], v234 offset:32768
    ds_read_b64_tr_b16 v[122:123], v234 offset:34816
    ds_read_b64_tr_b16 v[124:125], v235 offset:32768
    ds_read_b64_tr_b16 v[126:127], v235 offset:34816
    s_waitcnt lgkmcnt(4)
    ds_read_b64_tr_b16 v[128:129], v232 offset:36864
    ds_read_b64_tr_b16 v[130:131], v232 offset:38912
    ds_read_b64_tr_b16 v[132:133], v233 offset:36864
    ds_read_b64_tr_b16 v[134:135], v233 offset:38912
    ds_read_b64_tr_b16 v[136:137], v234 offset:36864
    ds_read_b64_tr_b16 v[138:139], v234 offset:38912
    ds_read_b64_tr_b16 v[140:141], v235 offset:36864
    ds_read_b64_tr_b16 v[142:143], v235 offset:38912
    s_waitcnt lgkmcnt(4)
    s_waitcnt lgkmcnt(0)
L_p2:
    s_waitcnt vmcnt(13)
    v_mfma_f32_16x16x32_bf16 v[200:203], v[32:35], v[144:147], 0
    v_mfma_f32_16x16x32_bf16 v[204:207], v[36:39], v[144:147], 0
    v_mfma_f32_16x16x32_bf16 v[208:211], v[40:43], v[144:147], 0
    v_mfma_f32_16x16x32_bf16 v[212:215], v[44:47], v[144:147], 0
    s_waitcnt vmcnt(12)
    v_mfma_f32_16x16x32_bf16 v[200:203], v[48:51], v[152:155], v[200:203]
    v_mfma_f32_16x16x32_bf16 v[204:207], v[52:55], v[152:155], v[204:207]
    v_mfma_f32_16x16x32_bf16 v[208:211], v[56:59], v[152:155], v[208:211]
    v_mfma_f32_16x16x32_bf16 v[212:215], v[60:63], v[152:155], v[212:215]
    s_waitcnt vmcnt(11)
    v_mfma_f32_16x16x32_bf16 v[200:203], v[64:67], v[160:163], v[200:203]
    v_mfma_f32_16x16x32_bf16 v[204:207], v[68:71], v[160:163], v[204:207]
    v_mfma_f32_16x16x32_bf16 v[208:211], v[72:75], v[160:163], v[208:211]
    v_mfma_f32_16x16x32_bf16 v[212:215], v[76:79], v[160:163], v[212:215]
    s_waitcnt vmcnt(10)
    v_mfma_f32_16x16x32_bf16 v[200:203], v[80:83], v[168:171], v[200:203]
    v_mfma_f32_16x16x32_bf16 v[204:207], v[84:87], v[168:171], v[204:207]
    v_mfma_f32_16x16x32_bf16 v[208:211], v[88:91], v[168:171], v[208:211]
    v_mfma_f32_16x16x32_bf16 v[212:215], v[92:95], v[168:171], v[212:215]
    s_waitcnt vmcnt(9)
    v_mfma_f32_16x16x32_bf16 v[200:203], v[96:99], v[176:179], v[200:203]
    v_mfma_f32_16x16x32_bf16 v[204:207], v[100:103], v[176:179], v[204:207]
    v_mfma_f32_16x16x32_bf16 v[208:211], v[104:107], v[176:179], v[208:211]
    v_mfma_f32_16x16x32_bf16 v[212:215], v[108:111], v[176:179], v[212:215]
    s_waitcnt vmcnt(8)
    v_mfma_f32_16x16x32_bf16 v[200:203], v[112:115], v[184:187], v[200:203]
    v_mfma_f32_16x16x32_bf16 v[204:207], v[116:119], v[184:187], v[204:207]
    v_mfma_f32_16x16x32_bf16 v[208:211], v[120:123], v[184:187], v[208:211]
    v_mfma_f32_16x16x32_bf16 v[212:215], v[124:127], v[184:187], v[212:215]
    s_waitcnt vmcnt(7)
    v_mfma_f32_16x16x32_bf16 v[200:203], v[128:131], v[192:195], v[200:203]
    v_mfma_f32_16x16x32_bf16 v[204:207], v[132:135], v[192:195], v[204:207]
    v_mfma_f32_16x16x32_bf16 v[208:211], v[136:139], v[192:195], v[208:211]
    v_mfma_f32_16x16x32_bf16 v[212:215], v[140:143], v[192:195], v[212:215]
    s_waitcnt vmcnt(6)
    v_mfma_f32_16x16x32_bf16 v[216:219], v[32:35], v[148:151], 0
    v_mfma_f32_16x16x32_bf16 v[220:223], v[36:39], v[148:151], 0
    v_mfma_f32_16x16x32_bf16 v[224:227], v[40:43], v[148:151], 0
    v_mfma_f32_16x16x32_bf16 v[228:231], v[44:47], v[148:151], 0
    s_waitcnt vmcnt(5)
    v_mfma_f32_16x16x32_bf16 v[216:219], v[48:51], v[156:159], v[216:219]
    v_mfma_f32_16x16x32_bf16 v[220:223], v[52:55], v[156:159], v[220:223]
    v_mfma_f32_16x16x32_bf16 v[224:227], v[56:59], v[156:159], v[224:227]
    v_mfma_f32_16x16x32_bf16 v[228:231], v[60:63], v[156:159], v[228:231]
    ds_write_b128 v24, v[200:203] offset:0
    s_waitcnt vmcnt(4)
    v_mfma_f32_16x16x32_bf16 v[216:219], v[64:67], v[164:167], v[216:219]
    v_mfma_f32_16x16x32_bf16 v[220:223], v[68:71], v[164:167], v[220:223]
    v_mfma_f32_16x16x32_bf16 v[224:227], v[72:75], v[164:167], v[224:227]
    v_mfma_f32_16x16x32_bf16 v[228:231], v[76:79], v[164:167], v[228:231]
    ds_write_b128 v25, v[204:207] offset:0
    s_waitcnt vmcnt(3)
    v_mfma_f32_16x16x32_bf16 v[216:219], v[80:83], v[172:175], v[216:219]
    v_mfma_f32_16x16x32_bf16 v[220:223], v[84:87], v[172:175], v[220:223]
    v_mfma_f32_16x16x32_bf16 v[224:227], v[88:91], v[172:175], v[224:227]
    v_mfma_f32_16x16x32_bf16 v[228:231], v[92:95], v[172:175], v[228:231]
    ds_write_b128 v24, v[208:211] offset:128
    s_waitcnt vmcnt(2)
    v_mfma_f32_16x16x32_bf16 v[216:219], v[96:99], v[180:183], v[216:219]
    v_mfma_f32_16x16x32_bf16 v[220:223], v[100:103], v[180:183], v[220:223]
    v_mfma_f32_16x16x32_bf16 v[224:227], v[104:107], v[180:183], v[224:227]
    v_mfma_f32_16x16x32_bf16 v[228:231], v[108:111], v[180:183], v[228:231]
    ds_write_b128 v25, v[212:215] offset:128
    s_waitcnt vmcnt(1)
    v_mfma_f32_16x16x32_bf16 v[216:219], v[112:115], v[188:191], v[216:219]
    v_mfma_f32_16x16x32_bf16 v[220:223], v[116:119], v[188:191], v[220:223]
    v_mfma_f32_16x16x32_bf16 v[224:227], v[120:123], v[188:191], v[224:227]
    v_mfma_f32_16x16x32_bf16 v[228:231], v[124:127], v[188:191], v[228:231]
    s_waitcnt vmcnt(0)
    v_mfma_f32_16x16x32_bf16 v[216:219], v[128:131], v[196:199], v[216:219]
    v_mfma_f32_16x16x32_bf16 v[220:223], v[132:135], v[196:199], v[220:223]
    v_mfma_f32_16x16x32_bf16 v[224:227], v[136:139], v[196:199], v[224:227]
    v_mfma_f32_16x16x32_bf16 v[228:231], v[140:143], v[196:199], v[228:231]
    s_nop 4
    ds_write_b128 v24, v[216:219] offset:4096
    s_nop 0
    ds_write_b128 v25, v[220:223] offset:4096
    s_nop 0
    ds_write_b128 v24, v[224:227] offset:4224
    s_nop 0
    ds_write_b128 v25, v[228:231] offset:4224
    s_waitcnt lgkmcnt(0)
    s_barrier
    ds_read_b128 v[32:35], v22 offset:0
    ds_read_b128 v[36:39], v22 offset:8192
    ds_read_b128 v[40:43], v22 offset:16384
    ds_read_b128 v[44:47], v22 offset:24576
    ds_read_b128 v[48:51], v22 offset:32768
    ds_read_b128 v[52:55], v22 offset:40960
    ds_read_b128 v[56:59], v22 offset:49152
    ds_read_b128 v[60:63], v22 offset:57344
    s_waitcnt lgkmcnt(6)
    v_pk_add_f32 v[32:33], v[32:33], v[36:37]
    v_pk_add_f32 v[34:35], v[34:35], v[38:39]
    s_waitcnt lgkmcnt(4)
    v_pk_add_f32 v[40:41], v[40:41], v[44:45]
    v_pk_add_f32 v[42:43], v[42:43], v[46:47]
    s_waitcnt lgkmcnt(2)
    v_pk_add_f32 v[48:49], v[48:49], v[52:53]
    v_pk_add_f32 v[50:51], v[50:51], v[54:55]
    v_pk_add_f32 v[32:33], v[32:33], v[40:41]
    v_pk_add_f32 v[34:35], v[34:35], v[42:43]
    s_waitcnt lgkmcnt(0)
    v_pk_add_f32 v[56:57], v[56:57], v[60:61]
    v_pk_add_f32 v[58:59], v[58:59], v[62:63]
    v_pk_add_f32 v[48:49], v[48:49], v[56:57]
    v_pk_add_f32 v[50:51], v[50:51], v[58:59]
    v_pk_add_f32 v[32:33], v[32:33], v[48:49]
    v_pk_add_f32 v[34:35], v[34:35], v[50:51]
    v_cvt_pk_bf16_f32 v36, v32, v33
    v_cvt_pk_bf16_f32 v37, v34, v35
    buffer_store_dwordx2 v[36:37], v23, s[32:35], 0 offen sc0 sc1
L_end:
    s_endpgm
.section .rodata,"a"
.p2align 6
.amdhsa_kernel standalone__swiglu_ffn__sampling_kernel
  .amdhsa_next_free_vgpr 256
  .amdhsa_next_free_sgpr 102
  .amdhsa_accum_offset 256
  .amdhsa_group_segment_fixed_size 0
  .amdhsa_kernarg_size 56
  .amdhsa_user_sgpr_count 2
  .amdhsa_user_sgpr_kernarg_segment_ptr 1
  .amdhsa_system_sgpr_workgroup_id_x 1
.end_amdhsa_kernel
```
